```python
import torch

def _softmax(x, axis=-1):
    return torch.softmax(x, dim=axis)
def _gelu(x):
    return torch.nn.functional.gelu(x, approximate="tanh")
def _silu(x):
    return torch.nn.functional.silu(x)
def _sigmoid(x):
    return torch.sigmoid(x)
def _layernorm(x, axis=-1, eps=1e-5):
    m = x.mean(dim=axis, keepdim=True)
    v = x.var(dim=axis, keepdim=True, unbiased=False)
    return (x - m) / torch.sqrt(v + eps)
def _scatter_add(tgt, idx, src, axis=0):
    return tgt.clone().index_add_(axis, idx, src)
def _segment_sum(src, seg, n):
    out = torch.zeros((n,) + src.shape[1:], dtype=src.dtype)
    return out.index_add_(0, seg, src)
def _pad(x, pw):
    flat = tuple(v for pair in reversed(pw) for v in pair)
    return torch.nn.functional.pad(x, flat)

kernel_name = 'recurrent_scan__sliding_block_cached__dense_activation_relu__decode'

def setup_inputs():

    _w = (lambda a: (lambda t: t.to(torch.bfloat16) if t.is_floating_point() else t)(torch.as_tensor(a)))
    def _A_setup():
        B, Sq, D = 2, 1, 640
        Hq, Hkv, Sk, Dh = 32, 32, 8192, 128
        assert Hq % Hkv == 0, (Hq, Hkv)
        return {
            "x": _w((lambda *s: torch.randn(*s, dtype=torch.bfloat16) * 0.05)(B, Sq, D)),
            "k_cache": _w((lambda *s: torch.randn(*s, dtype=torch.bfloat16) * 1.6)(B, Hkv, Sk, Dh)),
            "v_cache": _w((lambda *s: torch.randn(*s, dtype=torch.bfloat16) * 0.2)(B, Hkv, Sk, Dh)),
            "wq": _w((lambda *s: torch.randn(*s, dtype=torch.bfloat16) * 1.6)(D, Hq * Dh) * (D ** -0.5)),
            "wo": _w((lambda *s: torch.randn(*s, dtype=torch.bfloat16) * 0.2)(Hq * Dh, D) * ((Hq * Dh) ** -0.5)),
        }
    _A_in = _A_setup()

    def _B_setup():
        B, S, D, Dff = 2, 1, 640, 1728
        return {
            "x": _w((lambda *s: torch.randn(*s, dtype=torch.bfloat16) * 0.05)(B, S, D)),
            "w1": _w((lambda *s: torch.randn(*s, dtype=torch.bfloat16) * 0.1)(D, Dff)),
            "w2": _w((lambda *s: torch.randn(*s, dtype=torch.bfloat16) * 0.1)(Dff, D)),
        }
    _B_in = _B_setup()

    return {
        "A_x": _A_in["x"],
        "A_k_cache": _A_in["k_cache"],
        "A_v_cache": _A_in["v_cache"],
        "A_wq": _A_in["wq"],
        "A_wo": _A_in["wo"],
        "B_x": _B_in["x"],
        "B_w1": _B_in["w1"],
        "B_w2": _B_in["w2"],
    }

def reference(A_x, A_k_cache, A_v_cache, A_wq, A_wo, B_x, B_w1, B_w2):
    def _A_ref(x, k_cache, v_cache, wq, wo):
        B, Sq, D = x.shape
        Hq, Dh = 32, 128
        Hkv, Sk = k_cache.shape[1], k_cache.shape[2]
        W = min(4096, max(256, Sk // 4))
        rep = Hq // Hkv
        q = (lambda x, *d: x.permute(*d))((x @ wq).reshape(B, Sq, Hq, Dh), 0, 2, 1, 3)
        k = (lambda x, n, axis: torch.repeat_interleave(x, n, dim=axis))(k_cache[:, :, Sk - W:, :], rep, axis=1)
        v = (lambda x, n, axis: torch.repeat_interleave(x, n, dim=axis))(v_cache[:, :, Sk - W:, :], rep, axis=1)
        scores = torch.einsum("bhqd,bhkd->bhqk", q, k) * (Dh ** -0.5)
        p = _softmax(scores, axis=-1)
        o = torch.einsum("bhqk,bhkd->bhqd", p, v)
        return (lambda x, *d: x.permute(*d))(o, 0, 2, 1, 3).reshape(B, Sq, Hq * Dh) @ wo

    def _B_ref(x, w1, w2):
        h = torch.einsum("bsd,df->bsf", x, w1)
        zero = torch.zeros_like(h)
        h = torch.maximum(h, zero)
        return torch.einsum("bsf,fd->bsd", h, w2)

    x = A_x
    xn = _layernorm(x, axis=-1)
    s = _A_ref(xn, A_k_cache, A_v_cache, A_wq, A_wo)
    g = _silu(_B_ref(xn, B_w1, B_w2))
    return x + s * g
```

```asm
; @launch grid=(256,1,1) block=(768,1,1) lds=12288
.amdgcn_target "amdgcn-amd-amdhsa--gfx950"
.text
.globl recurrent_scan__sliding_block_cached__dense_activation_relu__decode_kernel
.p2align 8
.type recurrent_scan__sliding_block_cached__dense_activation_relu__decode_kernel,@function
recurrent_scan__sliding_block_cached__dense_activation_relu__decode_kernel:
  s_cmp_ge_u32 s2, 256
  s_cbranch_scc1 L_end
  s_memrealtime s[94:95]
  s_load_dwordx16 s[16:31], s[0:1], 0
  s_load_dwordx4 s[32:35], s[0:1], 64
  s_load_dwordx2 s[36:37], s[0:1], 80
  v_lshrrev_b32 v1, 6, v0
  v_and_b32 v0, 63, v0
  v_readfirstlane_b32 s3, v1
  s_lshr_b32 s4, s2, 3
  s_and_b32 s5, s2, 7
  s_lshr_b32 s6, s5, 2
  s_and_b32 s7, s5, 3
  s_mov_b32 s11, s2
  v_mov_b32 v1, 0
  v_mov_b32 v2, 1
  s_cmp_eq_u32 s3, 3
  s_cbranch_scc0 L_noinit
  s_getpc_b64 s[50:51]
L_pc0:
  s_sub_u32 s50, s50, L_pc0-recurrent_scan__sliding_block_cached__dense_activation_relu__decode_kernel
  s_subb_u32 s51, s51, 0
  v_lshlrev_b32 v3, 7, v0
  v_min_u32 v4, L_end-recurrent_scan__sliding_block_cached__dense_activation_relu__decode_kernel, v3
  global_load_dword v16, v4, s[50:51]
  v_add_u32 v3, 8192, v3
  v_min_u32 v4, L_end-recurrent_scan__sliding_block_cached__dense_activation_relu__decode_kernel, v3
  global_load_dword v17, v4, s[50:51]
  v_add_u32 v3, 8192, v3
  v_min_u32 v4, L_end-recurrent_scan__sliding_block_cached__dense_activation_relu__decode_kernel, v3
  global_load_dword v18, v4, s[50:51]
  v_lshlrev_b32 v3, 2, v0
  ds_write_b32 v3, v1
  s_waitcnt lgkmcnt(0)
L_noinit:
  s_barrier
  s_cmp_lt_u32 s3, 4
  s_cbranch_scc1 L_aux
  s_and_b32 s10, s3, 3
  s_lshl_b32 s12, s6, 26
  s_lshl_b32 s13, s4, 21
  s_add_u32 s12, s12, s13
  s_lshl_b32 s13, s7, 17
  s_add_u32 s12, s12, s13
  s_lshl_b32 s13, s10, 15
  s_add_u32 s12, s12, s13
  s_add_u32 s12, s12, 1572864
  v_lshlrev_b32 v3, 4, v0
  s_lshl_b32 s13, s10, 2
  v_mov_b32 v4, s13
  s_lshl_b32 s45, s11, 2
  s_add_u32 s45, s45, s10
  s_add_u32 s45, s45, 1
  s_mul_i32 s45, s45, 2654435761
  s_lshr_b32 s45, s45, 27
  s_lshl_b32 s45, s45, 10
  s_cmp_ge_u32 s3, 8
  s_cbranch_scc1 L_vpre
  s_setprio 1
  s_waitcnt lgkmcnt(0)
  s_mov_b32 s40, s18
  s_and_b32 s41, s19, 0xffff
  s_mov_b32 s42, 134217728
  s_mov_b32 s43, 0x20000
  v_add_u32 v5, 48, v4
  s_branch L_issue
L_vpre:
  v_add_u32 v5, 64, v4
  s_mov_b32 s9, 0
L_wl_1:
  ds_read_b32 v8, v4 offset:48
  s_waitcnt lgkmcnt(0)
  v_readfirstlane_b32 s8, v8
  s_cmp_lg_u32 s8, 0
  s_cbranch_scc1 L_wld_2
  s_sleep 4
  s_add_u32 s9, s9, 1
  s_cmp_lt_u32 s9, 2097152
  s_cbranch_scc1 L_wl_1
L_wld_2:
  s_mov_b32 s40, s20
  s_and_b32 s41, s21, 0xffff
  s_mov_b32 s42, 134217728
  s_mov_b32 s43, 0x20000
  s_branch L_vissue
L_issue:
  s_add_u32 s44, s12, s45
  buffer_load_dwordx4 v[16:19], v3, s[40:43], s44 offen nt
  s_add_u32 s45, s45, 1024
  s_and_b32 s45, s45, 0x7fff
  s_add_u32 s44, s12, s45
  buffer_load_dwordx4 v[20:23], v3, s[40:43], s44 offen nt
  s_add_u32 s45, s45, 1024
  s_and_b32 s45, s45, 0x7fff
  s_add_u32 s44, s12, s45
  buffer_load_dwordx4 v[24:27], v3, s[40:43], s44 offen nt
  s_add_u32 s45, s45, 1024
  s_and_b32 s45, s45, 0x7fff
  s_add_u32 s44, s12, s45
  buffer_load_dwordx4 v[28:31], v3, s[40:43], s44 offen nt
  s_add_u32 s45, s45, 1024
  s_and_b32 s45, s45, 0x7fff
  s_add_u32 s44, s12, s45
  buffer_load_dwordx4 v[32:35], v3, s[40:43], s44 offen nt
  s_add_u32 s45, s45, 1024
  s_and_b32 s45, s45, 0x7fff
  s_add_u32 s44, s12, s45
  buffer_load_dwordx4 v[36:39], v3, s[40:43], s44 offen nt
  s_add_u32 s45, s45, 1024
  s_and_b32 s45, s45, 0x7fff
  s_add_u32 s44, s12, s45
  buffer_load_dwordx4 v[40:43], v3, s[40:43], s44 offen nt
  s_add_u32 s45, s45, 1024
  s_and_b32 s45, s45, 0x7fff
  s_add_u32 s44, s12, s45
  buffer_load_dwordx4 v[44:47], v3, s[40:43], s44 offen nt
  s_add_u32 s45, s45, 1024
  s_and_b32 s45, s45, 0x7fff
  s_waitcnt vmcnt(7)
  s_add_u32 s44, s12, s45
  buffer_load_dwordx4 v[48:51], v3, s[40:43], s44 offen nt
  s_add_u32 s45, s45, 1024
  s_and_b32 s45, s45, 0x7fff
  s_waitcnt vmcnt(7)
  s_add_u32 s44, s12, s45
  buffer_load_dwordx4 v[52:55], v3, s[40:43], s44 offen nt
  s_add_u32 s45, s45, 1024
  s_and_b32 s45, s45, 0x7fff
  s_waitcnt vmcnt(7)
  s_add_u32 s44, s12, s45
  buffer_load_dwordx4 v[56:59], v3, s[40:43], s44 offen nt
  s_add_u32 s45, s45, 1024
  s_and_b32 s45, s45, 0x7fff
  s_waitcnt vmcnt(7)
  s_add_u32 s44, s12, s45
  buffer_load_dwordx4 v[60:63], v3, s[40:43], s44 offen nt
  s_add_u32 s45, s45, 1024
  s_and_b32 s45, s45, 0x7fff
  s_waitcnt vmcnt(7)
  s_add_u32 s44, s12, s45
  buffer_load_dwordx4 v[64:67], v3, s[40:43], s44 offen nt
  s_add_u32 s45, s45, 1024
  s_and_b32 s45, s45, 0x7fff
  s_waitcnt vmcnt(7)
  s_add_u32 s44, s12, s45
  buffer_load_dwordx4 v[68:71], v3, s[40:43], s44 offen nt
  s_add_u32 s45, s45, 1024
  s_and_b32 s45, s45, 0x7fff
  s_waitcnt vmcnt(7)
  s_add_u32 s44, s12, s45
  buffer_load_dwordx4 v[72:75], v3, s[40:43], s44 offen nt
  s_add_u32 s45, s45, 1024
  s_and_b32 s45, s45, 0x7fff
  s_waitcnt vmcnt(7)
  s_add_u32 s44, s12, s45
  buffer_load_dwordx4 v[76:79], v3, s[40:43], s44 offen nt
  s_add_u32 s45, s45, 1024
  s_and_b32 s45, s45, 0x7fff
  s_waitcnt vmcnt(7)
  s_add_u32 s44, s12, s45
  buffer_load_dwordx4 v[80:83], v3, s[40:43], s44 offen nt
  s_add_u32 s45, s45, 1024
  s_and_b32 s45, s45, 0x7fff
  s_waitcnt vmcnt(7)
  s_add_u32 s44, s12, s45
  buffer_load_dwordx4 v[84:87], v3, s[40:43], s44 offen nt
  s_add_u32 s45, s45, 1024
  s_and_b32 s45, s45, 0x7fff
  s_waitcnt vmcnt(7)
  s_add_u32 s44, s12, s45
  buffer_load_dwordx4 v[88:91], v3, s[40:43], s44 offen nt
  s_add_u32 s45, s45, 1024
  s_and_b32 s45, s45, 0x7fff
  s_waitcnt vmcnt(7)
  s_add_u32 s44, s12, s45
  buffer_load_dwordx4 v[92:95], v3, s[40:43], s44 offen nt
  s_add_u32 s45, s45, 1024
  s_and_b32 s45, s45, 0x7fff
  s_waitcnt vmcnt(7)
  s_add_u32 s44, s12, s45
  buffer_load_dwordx4 v[96:99], v3, s[40:43], s44 offen nt
  s_add_u32 s45, s45, 1024
  s_and_b32 s45, s45, 0x7fff
  s_waitcnt vmcnt(7)
  s_add_u32 s44, s12, s45
  buffer_load_dwordx4 v[100:103], v3, s[40:43], s44 offen nt
  s_add_u32 s45, s45, 1024
  s_and_b32 s45, s45, 0x7fff
  s_waitcnt vmcnt(7)
  s_add_u32 s44, s12, s45
  buffer_load_dwordx4 v[104:107], v3, s[40:43], s44 offen nt
  s_add_u32 s45, s45, 1024
  s_and_b32 s45, s45, 0x7fff
  s_waitcnt vmcnt(7)
  s_add_u32 s44, s12, s45
  buffer_load_dwordx4 v[108:111], v3, s[40:43], s44 offen nt
  s_add_u32 s45, s45, 1024
  s_and_b32 s45, s45, 0x7fff
  s_waitcnt vmcnt(7)
  s_add_u32 s44, s12, s45
  buffer_load_dwordx4 v[112:115], v3, s[40:43], s44 offen nt
  s_add_u32 s45, s45, 1024
  s_and_b32 s45, s45, 0x7fff
  s_waitcnt vmcnt(7)
  s_add_u32 s44, s12, s45
  buffer_load_dwordx4 v[116:119], v3, s[40:43], s44 offen nt
  s_add_u32 s45, s45, 1024
  s_and_b32 s45, s45, 0x7fff
  s_waitcnt vmcnt(7)
  s_add_u32 s44, s12, s45
  buffer_load_dwordx4 v[120:123], v3, s[40:43], s44 offen nt
  s_add_u32 s45, s45, 1024
  s_and_b32 s45, s45, 0x7fff
  s_waitcnt vmcnt(7)
  s_add_u32 s44, s12, s45
  buffer_load_dwordx4 v[124:127], v3, s[40:43], s44 offen nt
  s_add_u32 s45, s45, 1024
  s_and_b32 s45, s45, 0x7fff
  s_waitcnt vmcnt(7)
  s_add_u32 s44, s12, s45
  buffer_load_dwordx4 v[128:131], v3, s[40:43], s44 offen nt
  s_add_u32 s45, s45, 1024
  s_and_b32 s45, s45, 0x7fff
  s_waitcnt vmcnt(7)
  s_add_u32 s44, s12, s45
  buffer_load_dwordx4 v[132:135], v3, s[40:43], s44 offen nt
  s_add_u32 s45, s45, 1024
  s_and_b32 s45, s45, 0x7fff
  s_waitcnt vmcnt(7)
  s_add_u32 s44, s12, s45
  buffer_load_dwordx4 v[136:139], v3, s[40:43], s44 offen nt
  s_add_u32 s45, s45, 1024
  s_and_b32 s45, s45, 0x7fff
  s_waitcnt vmcnt(7)
  s_add_u32 s44, s12, s45
  buffer_load_dwordx4 v[140:143], v3, s[40:43], s44 offen nt
  s_add_u32 s45, s45, 1024
  s_and_b32 s45, s45, 0x7fff
  ds_write_b32 v5, v2
  s_branch L_kwave
L_aux:
  s_setprio 3
  s_cmp_eq_u32 s3, 2
  s_cbranch_scc1 L_aux2
  s_cmp_eq_u32 s3, 3
  s_cbranch_scc1 L_aux3
  v_lshrrev_b32 v3, 5, v0
  v_and_b32 v4, 31, v0
  v_mul_u32_u24 v5, 1280, v3
  v_lshl_add_u32 v6, v4, 3, v5
  v_min_u32 v7, 19, v4
  v_lshl_add_u32 v7, v7, 3, v5
  s_mul_i32 s8, s5, 160
  v_add_u32 v7, s8, v7
  v_lshrrev_b32 v8, 4, v0
  v_and_b32 v9, 15, v0
  s_waitcnt lgkmcnt(0)
  global_load_dwordx2 v[20:21], v6, s[16:17] offset:0
  global_load_dwordx2 v[22:23], v6, s[16:17] offset:256
  global_load_dwordx2 v[24:25], v6, s[16:17] offset:512
  global_load_dwordx2 v[26:27], v6, s[16:17] offset:768
  global_load_dwordx2 v[28:29], v6, s[16:17] offset:1024
  global_load_dwordx2 v[30:31], v7, s[16:17]
  s_cmp_eq_u32 s3, 1
  s_cbranch_scc1 L_iss1
  s_mov_b32 s40, s22
  s_and_b32 s41, s23, 0xffff
  s_mov_b32 s42, 5242880
  s_mov_b32 s43, 0x20000
  v_lshlrev_b32 v10, 13, v8
  v_lshl_add_u32 v10, v9, 4, v10
  s_mul_i32 s12, s5, 80*8192
  s_lshl_b32 s13, s4, 8
  s_add_u32 s12, s12, s13
  buffer_load_dwordx4 v[40:43], v10, s[40:43], s12 offen nt
  s_add_u32 s12, s12, 32768
  buffer_load_dwordx4 v[44:47], v10, s[40:43], s12 offen nt
  s_add_u32 s12, s12, 32768
  buffer_load_dwordx4 v[48:51], v10, s[40:43], s12 offen nt
  s_add_u32 s12, s12, 32768
  buffer_load_dwordx4 v[52:55], v10, s[40:43], s12 offen nt
  s_add_u32 s12, s12, 32768
  buffer_load_dwordx4 v[56:59], v10, s[40:43], s12 offen nt
  s_add_u32 s12, s12, 32768
  buffer_load_dwordx4 v[60:63], v10, s[40:43], s12 offen nt
  s_add_u32 s12, s12, 32768
  buffer_load_dwordx4 v[64:67], v10, s[40:43], s12 offen nt
  s_add_u32 s12, s12, 32768
  buffer_load_dwordx4 v[68:71], v10, s[40:43], s12 offen nt
  s_add_u32 s12, s12, 32768
  buffer_load_dwordx4 v[72:75], v10, s[40:43], s12 offen nt
  s_add_u32 s12, s12, 32768
  buffer_load_dwordx4 v[76:79], v10, s[40:43], s12 offen nt
  s_add_u32 s12, s12, 32768
  buffer_load_dwordx4 v[80:83], v10, s[40:43], s12 offen nt
  s_add_u32 s12, s12, 32768
  buffer_load_dwordx4 v[84:87], v10, s[40:43], s12 offen nt
  s_add_u32 s12, s12, 32768
  buffer_load_dwordx4 v[88:91], v10, s[40:43], s12 offen nt
  s_add_u32 s12, s12, 32768
  buffer_load_dwordx4 v[92:95], v10, s[40:43], s12 offen nt
  s_add_u32 s12, s12, 32768
  buffer_load_dwordx4 v[96:99], v10, s[40:43], s12 offen nt
  s_add_u32 s12, s12, 32768
  buffer_load_dwordx4 v[100:103], v10, s[40:43], s12 offen nt
  s_add_u32 s12, s12, 32768
  buffer_load_dwordx4 v[104:107], v10, s[40:43], s12 offen nt
  s_add_u32 s12, s12, 32768
  buffer_load_dwordx4 v[108:111], v10, s[40:43], s12 offen nt
  s_add_u32 s12, s12, 32768
  buffer_load_dwordx4 v[112:115], v10, s[40:43], s12 offen nt
  s_add_u32 s12, s12, 32768
  buffer_load_dwordx4 v[116:119], v10, s[40:43], s12 offen nt
  s_branch L_ln
L_iss1:
  s_mov_b32 s40, s28
  s_and_b32 s41, s29, 0xffff
  s_mov_b32 s42, 2211840
  s_mov_b32 s43, 0x20000
  s_cmp_ge_u32 s4, 27
  s_cbranch_scc1 L_end
  v_mul_u32_u24 v10, 3456, v8
  v_lshl_add_u32 v10, v9, 3, v10
  s_mul_i32 s12, s5, 80*3456
  s_lshl_b32 s13, s4, 7
  s_add_u32 s12, s12, s13
  buffer_load_dwordx2 v[40:41], v10, s[40:43], s12 offen nt
  s_add_u32 s12, s12, 13824
  buffer_load_dwordx2 v[42:43], v10, s[40:43], s12 offen nt
  s_add_u32 s12, s12, 13824
  buffer_load_dwordx2 v[44:45], v10, s[40:43], s12 offen nt
  s_add_u32 s12, s12, 13824
  buffer_load_dwordx2 v[46:47], v10, s[40:43], s12 offen nt
  s_add_u32 s12, s12, 13824
  buffer_load_dwordx2 v[48:49], v10, s[40:43], s12 offen nt
  s_add_u32 s12, s12, 13824
  buffer_load_dwordx2 v[50:51], v10, s[40:43], s12 offen nt
  s_add_u32 s12, s12, 13824
  buffer_load_dwordx2 v[52:53], v10, s[40:43], s12 offen nt
  s_add_u32 s12, s12, 13824
  buffer_load_dwordx2 v[54:55], v10, s[40:43], s12 offen nt
  s_add_u32 s12, s12, 13824
  buffer_load_dwordx2 v[56:57], v10, s[40:43], s12 offen nt
  s_add_u32 s12, s12, 13824
  buffer_load_dwordx2 v[58:59], v10, s[40:43], s12 offen nt
  s_add_u32 s12, s12, 13824
  buffer_load_dwordx2 v[60:61], v10, s[40:43], s12 offen nt
  s_add_u32 s12, s12, 13824
  buffer_load_dwordx2 v[62:63], v10, s[40:43], s12 offen nt
  s_add_u32 s12, s12, 13824
  buffer_load_dwordx2 v[64:65], v10, s[40:43], s12 offen nt
  s_add_u32 s12, s12, 13824
  buffer_load_dwordx2 v[66:67], v10, s[40:43], s12 offen nt
  s_add_u32 s12, s12, 13824
  buffer_load_dwordx2 v[68:69], v10, s[40:43], s12 offen nt
  s_add_u32 s12, s12, 13824
  buffer_load_dwordx2 v[70:71], v10, s[40:43], s12 offen nt
  s_add_u32 s12, s12, 13824
  buffer_load_dwordx2 v[72:73], v10, s[40:43], s12 offen nt
  s_add_u32 s12, s12, 13824
  buffer_load_dwordx2 v[74:75], v10, s[40:43], s12 offen nt
  s_add_u32 s12, s12, 13824
  buffer_load_dwordx2 v[76:77], v10, s[40:43], s12 offen nt
  s_add_u32 s12, s12, 13824
  buffer_load_dwordx2 v[78:79], v10, s[40:43], s12 offen nt
  s_branch L_wsk0
L_w0:
  s_branch L_w1
L_wsk0:
L_ln:
  s_mul_i32 s13, s3, 768
  v_mul_u32_u24 v143, 320, v3
  v_lshl_add_u32 v143, v4, 2, v143
  v_add_u32 v143, s13, v143
  s_waitcnt vmcnt(21)
  v_lshlrev_b32 v120, 16, v20
  v_and_b32 v121, 0xffff0000, v20
  v_lshlrev_b32 v122, 16, v21
  v_and_b32 v123, 0xffff0000, v21
  v_lshlrev_b32 v124, 16, v22
  v_and_b32 v125, 0xffff0000, v22
  v_lshlrev_b32 v126, 16, v23
  v_and_b32 v127, 0xffff0000, v23
  v_lshlrev_b32 v128, 16, v24
  v_and_b32 v129, 0xffff0000, v24
  v_lshlrev_b32 v130, 16, v25
  v_and_b32 v131, 0xffff0000, v25
  v_lshlrev_b32 v132, 16, v26
  v_and_b32 v133, 0xffff0000, v26
  v_lshlrev_b32 v134, 16, v27
  v_and_b32 v135, 0xffff0000, v27
  v_lshlrev_b32 v136, 16, v28
  v_and_b32 v137, 0xffff0000, v28
  v_lshlrev_b32 v138, 16, v29
  v_and_b32 v139, 0xffff0000, v29
  v_add_f32 v144, v120, v121
  v_add_f32 v145, v122, v123
  v_add_f32 v146, v124, v125
  v_add_f32 v147, v126, v127
  v_add_f32 v148, v128, v129
  v_add_f32 v149, v130, v131
  v_add_f32 v150, v132, v133
  v_add_f32 v151, v134, v135
  v_add_f32 v152, v136, v137
  v_add_f32 v153, v138, v139
  v_add_f32 v144, v144, v149
  v_add_f32 v145, v145, v150
  v_add_f32 v146, v146, v151
  v_add_f32 v147, v147, v152
  v_add_f32 v148, v148, v153
  v_add_f32 v144, v144, v145
  v_add_f32 v146, v146, v147
  v_add_f32 v144, v144, v148
  v_add_f32 v140, v144, v146
  s_mov_b32 s12, 0xc4200000
  s_nop 0
  v_add_f32_dpp v140, v140, v140 row_ror:8 row_mask:0xf bank_mask:0xf
  s_nop 1
  v_add_f32_dpp v140, v140, v140 row_ror:4 row_mask:0xf bank_mask:0xf
  s_nop 1
  v_add_f32_dpp v140, v140, v140 row_ror:2 row_mask:0xf bank_mask:0xf
  s_nop 1
  v_add_f32_dpp v140, v140, v140 row_ror:1 row_mask:0xf bank_mask:0xf
  v_mov_b32 v141, v140
  s_nop 1
  v_permlane16_swap_b32 v140, v141
  v_add_f32 v140, v140, v141
  v_mul_f32 v141, 0x3acccccd, v140
  v_fma_f32 v142, v141, s12, v140
  v_fmac_f32 v141, 0x3acccccd, v142
  v_mov_b32 v140, v141
  v_sub_f32 v120, v120, v140
  v_sub_f32 v121, v121, v140
  v_sub_f32 v122, v122, v140
  v_sub_f32 v123, v123, v140
  v_sub_f32 v124, v124, v140
  v_sub_f32 v125, v125, v140
  v_sub_f32 v126, v126, v140
  v_sub_f32 v127, v127, v140
  v_sub_f32 v128, v128, v140
  v_sub_f32 v129, v129, v140
  v_sub_f32 v130, v130, v140
  v_sub_f32 v131, v131, v140
  v_sub_f32 v132, v132, v140
  v_sub_f32 v133, v133, v140
  v_sub_f32 v134, v134, v140
  v_sub_f32 v135, v135, v140
  v_sub_f32 v136, v136, v140
  v_sub_f32 v137, v137, v140
  v_sub_f32 v138, v138, v140
  v_sub_f32 v139, v139, v140
  v_mul_f32 v141, v120, v120
  v_mul_f32 v142, v121, v121
  v_fmac_f32 v141, v122, v122
  v_fmac_f32 v142, v123, v123
  v_fmac_f32 v141, v124, v124
  v_fmac_f32 v142, v125, v125
  v_fmac_f32 v141, v126, v126
  v_fmac_f32 v142, v127, v127
  v_fmac_f32 v141, v128, v128
  v_fmac_f32 v142, v129, v129
  v_fmac_f32 v141, v130, v130
  v_fmac_f32 v142, v131, v131
  v_fmac_f32 v141, v132, v132
  v_fmac_f32 v142, v133, v133
  v_fmac_f32 v141, v134, v134
  v_fmac_f32 v142, v135, v135
  v_fmac_f32 v141, v136, v136
  v_fmac_f32 v142, v137, v137
  v_fmac_f32 v141, v138, v138
  v_fmac_f32 v142, v139, v139
  v_add_f32 v141, v141, v142
  s_nop 1
  v_add_f32_dpp v141, v141, v141 row_ror:8 row_mask:0xf bank_mask:0xf
  s_nop 1
  v_add_f32_dpp v141, v141, v141 row_ror:4 row_mask:0xf bank_mask:0xf
  s_nop 1
  v_add_f32_dpp v141, v141, v141 row_ror:2 row_mask:0xf bank_mask:0xf
  s_nop 1
  v_add_f32_dpp v141, v141, v141 row_ror:1 row_mask:0xf bank_mask:0xf
  v_mov_b32 v142, v141
  s_nop 1
  v_permlane16_swap_b32 v141, v142
  v_add_f32 v141, v141, v142
  v_mul_f32 v142, 0x3acccccd, v141
  v_fma_f32 v144, v142, s12, v141
  v_fmac_f32 v142, 0x3acccccd, v144
  v_mov_b32 v141, v142
  v_cvt_pk_bf16_f32 v140, v140, v140
  v_lshlrev_b32 v140, 16, v140
  v_cvt_pk_bf16_f32 v141, v141, v141
  v_lshlrev_b32 v141, 16, v141
  v_add_f32 v141, 0x3727c5ac, v141
  v_cvt_pk_bf16_f32 v141, v141, v141
  v_lshlrev_b32 v141, 16, v141
  v_sqrt_f32 v141, v141
  s_nop 0
  v_cvt_pk_bf16_f32 v141, v141, v141
  v_lshlrev_b32 v141, 16, v141
  v_rcp_f32 v142, v141
  s_waitcnt vmcnt(20)
  v_lshlrev_b32 v144, 16, v30
  v_and_b32 v145, 0xffff0000, v30
  v_lshlrev_b32 v146, 16, v31
  v_and_b32 v147, 0xffff0000, v31
  v_sub_f32 v144, v144, v140
  v_sub_f32 v145, v145, v140
  v_sub_f32 v146, v146, v140
  v_sub_f32 v147, v147, v140
  v_cvt_pk_bf16_f32 v144, v144, v144
  v_lshlrev_b32 v144, 16, v144
  v_cvt_pk_bf16_f32 v145, v145, v145
  v_lshlrev_b32 v145, 16, v145
  v_cvt_pk_bf16_f32 v146, v146, v146
  v_lshlrev_b32 v146, 16, v146
  v_cvt_pk_bf16_f32 v147, v147, v147
  v_lshlrev_b32 v147, 16, v147
  v_mul_f32 v148, v144, v142
  v_mul_f32 v149, v145, v142
  v_mul_f32 v150, v146, v142
  v_mul_f32 v151, v147, v142
  v_fma_f32 v152, -v148, v141, v144
  v_fma_f32 v153, -v149, v141, v145
  v_fma_f32 v154, -v150, v141, v146
  v_fma_f32 v155, -v151, v141, v147
  v_fmac_f32 v148, v152, v142
  v_fmac_f32 v149, v153, v142
  v_fmac_f32 v150, v154, v142
  v_fmac_f32 v151, v155, v142
  v_cvt_pk_bf16_f32 v148, v148, v148
  v_cvt_pk_bf16_f32 v149, v149, v149
  v_cvt_pk_bf16_f32 v150, v150, v150
  v_cvt_pk_bf16_f32 v151, v151, v151
  s_mov_b32 exec_lo, 0xfffff
  s_mov_b32 exec_hi, 0xfffff
  ds_write_b32 v143, v148 offset:1024
  ds_write_b32 v143, v149 offset:1104
  ds_write_b32 v143, v150 offset:1184
  ds_write_b32 v143, v151 offset:1264
  s_mov_b64 exec, -1
  s_branch L_wsk1
L_w1:
  s_branch L_w2
L_wsk1:
  s_cmp_eq_u32 s3, 1
  s_cbranch_scc1 L_aux1
L_aux0:
  v_and_b32 v160, 1, v0
  v_lshlrev_b32 v160, 4, v160
  v_mov_b32 v161, 0xffff
  v_lshlrev_b32 v160, v160, v161
  v_bfe_u32 v161, v0, 1, 2
  v_cmp_eq_u32 vcc, 0, v161
  s_nop 1
  v_cndmask_b32 v156, 0, v160, vcc
  v_cmp_eq_u32 vcc, 1, v161
  s_nop 1
  v_cndmask_b32 v157, 0, v160, vcc
  v_cmp_eq_u32 vcc, 2, v161
  s_nop 1
  v_cndmask_b32 v158, 0, v160, vcc
  v_cmp_eq_u32 vcc, 3, v161
  s_nop 1
  v_cndmask_b32 v159, 0, v160, vcc
  v_bfe_u32 v11, v0, 3, 1
  v_lshl_add_u32 v11, v11, 2, v8
  v_mul_u32_u24 v11, 80, v11
  s_waitcnt lgkmcnt(0)
  ds_read_b128 v[120:123], v11 offset:1024
  ds_read_b128 v[124:127], v11 offset:1040
  ds_read_b128 v[128:131], v11 offset:1056
  ds_read_b128 v[132:135], v11 offset:1072
  ds_read_b128 v[136:139], v11 offset:1088
  v_lshrrev_b32 v12, 1, v8
  v_lshlrev_b32 v12, 9, v12
  v_lshl_add_u32 v12, v9, 5, v12
  v_and_b32 v13, 1, v8
  v_lshl_add_u32 v12, v13, 4, v12
  s_lshl_b32 s12, s11, 10
  v_add_u32 v12, s12, v12
  v_mov_b32 v14, 0xff
  s_waitcnt lgkmcnt(0)
  v_and_b32 v140, v120, v156
  v_and_b32 v141, v120, v157
  v_and_b32 v142, v120, v158
  v_and_b32 v143, v120, v159
  s_waitcnt vmcnt(19)
  s_nop 0
  v_mfma_f32_16x16x32_bf16 v[148:151], v[140:143], v[40:43], 0
  v_and_b32 v144, v121, v156
  v_and_b32 v145, v121, v157
  v_and_b32 v146, v121, v158
  v_and_b32 v147, v121, v159
  s_waitcnt vmcnt(18)
  s_nop 0
  v_mfma_f32_16x16x32_bf16 v[148:151], v[144:147], v[44:47], v[148:151]
  v_and_b32 v140, v122, v156
  v_and_b32 v141, v122, v157
  v_and_b32 v142, v122, v158
  v_and_b32 v143, v122, v159
  s_waitcnt vmcnt(17)
  s_nop 0
  v_mfma_f32_16x16x32_bf16 v[148:151], v[140:143], v[48:51], v[148:151]
  v_and_b32 v144, v123, v156
  v_and_b32 v145, v123, v157
  v_and_b32 v146, v123, v158
  v_and_b32 v147, v123, v159
  s_waitcnt vmcnt(16)
  s_nop 0
  v_mfma_f32_16x16x32_bf16 v[148:151], v[144:147], v[52:55], v[148:151]
  v_and_b32 v140, v124, v156
  v_and_b32 v141, v124, v157
  v_and_b32 v142, v124, v158
  v_and_b32 v143, v124, v159
  s_waitcnt vmcnt(15)
  s_nop 0
  v_mfma_f32_16x16x32_bf16 v[148:151], v[140:143], v[56:59], v[148:151]
  v_and_b32 v144, v125, v156
  v_and_b32 v145, v125, v157
  v_and_b32 v146, v125, v158
  v_and_b32 v147, v125, v159
  s_waitcnt vmcnt(14)
  s_nop 0
  v_mfma_f32_16x16x32_bf16 v[148:151], v[144:147], v[60:63], v[148:151]
  v_and_b32 v140, v126, v156
  v_and_b32 v141, v126, v157
  v_and_b32 v142, v126, v158
  v_and_b32 v143, v126, v159
  s_waitcnt vmcnt(13)
  s_nop 0
  v_mfma_f32_16x16x32_bf16 v[148:151], v[140:143], v[64:67], v[148:151]
  v_and_b32 v144, v127, v156
  v_and_b32 v145, v127, v157
  v_and_b32 v146, v127, v158
  v_and_b32 v147, v127, v159
  s_waitcnt vmcnt(12)
  s_nop 0
  v_mfma_f32_16x16x32_bf16 v[148:151], v[144:147], v[68:71], v[148:151]
  v_and_b32 v140, v128, v156
  v_and_b32 v141, v128, v157
  v_and_b32 v142, v128, v158
  v_and_b32 v143, v128, v159
  s_waitcnt vmcnt(11)
  s_nop 0
  v_mfma_f32_16x16x32_bf16 v[148:151], v[140:143], v[72:75], v[148:151]
  v_and_b32 v144, v129, v156
  v_and_b32 v145, v129, v157
  v_and_b32 v146, v129, v158
  v_and_b32 v147, v129, v159
  s_waitcnt vmcnt(10)
  s_nop 0
  v_mfma_f32_16x16x32_bf16 v[148:151], v[144:147], v[76:79], v[148:151]
  v_and_b32 v140, v130, v156
  v_and_b32 v141, v130, v157
  v_and_b32 v142, v130, v158
  v_and_b32 v143, v130, v159
  s_waitcnt vmcnt(9)
  s_nop 0
  v_mfma_f32_16x16x32_bf16 v[148:151], v[140:143], v[80:83], v[148:151]
  v_and_b32 v144, v131, v156
  v_and_b32 v145, v131, v157
  v_and_b32 v146, v131, v158
  v_and_b32 v147, v131, v159
  s_waitcnt vmcnt(8)
  s_nop 0
  v_mfma_f32_16x16x32_bf16 v[148:151], v[144:147], v[84:87], v[148:151]
  v_and_b32 v140, v132, v156
  v_and_b32 v141, v132, v157
  v_and_b32 v142, v132, v158
  v_and_b32 v143, v132, v159
  s_waitcnt vmcnt(7)
  s_nop 0
  v_mfma_f32_16x16x32_bf16 v[148:151], v[140:143], v[88:91], v[148:151]
  v_and_b32 v144, v133, v156
  v_and_b32 v145, v133, v157
  v_and_b32 v146, v133, v158
  v_and_b32 v147, v133, v159
  s_waitcnt vmcnt(6)
  s_nop 0
  v_mfma_f32_16x16x32_bf16 v[148:151], v[144:147], v[92:95], v[148:151]
  v_and_b32 v140, v134, v156
  v_and_b32 v141, v134, v157
  v_and_b32 v142, v134, v158
  v_and_b32 v143, v134, v159
  s_waitcnt vmcnt(5)
  s_nop 0
  v_mfma_f32_16x16x32_bf16 v[148:151], v[140:143], v[96:99], v[148:151]
  v_and_b32 v144, v135, v156
  v_and_b32 v145, v135, v157
  v_and_b32 v146, v135, v158
  v_and_b32 v147, v135, v159
  s_waitcnt vmcnt(4)
  s_nop 0
  v_mfma_f32_16x16x32_bf16 v[148:151], v[144:147], v[100:103], v[148:151]
  v_and_b32 v140, v136, v156
  v_and_b32 v141, v136, v157
  v_and_b32 v142, v136, v158
  v_and_b32 v143, v136, v159
  s_waitcnt vmcnt(3)
  s_nop 0
  v_mfma_f32_16x16x32_bf16 v[148:151], v[140:143], v[104:107], v[148:151]
  v_and_b32 v144, v137, v156
  v_and_b32 v145, v137, v157
  v_and_b32 v146, v137, v158
  v_and_b32 v147, v137, v159
  s_waitcnt vmcnt(2)
  s_nop 0
  v_mfma_f32_16x16x32_bf16 v[148:151], v[144:147], v[108:111], v[148:151]
  v_and_b32 v140, v138, v156
  v_and_b32 v141, v138, v157
  v_and_b32 v142, v138, v158
  v_and_b32 v143, v138, v159
  s_waitcnt vmcnt(1)
  s_nop 0
  v_mfma_f32_16x16x32_bf16 v[148:151], v[140:143], v[112:115], v[148:151]
  v_and_b32 v144, v139, v156
  v_and_b32 v145, v139, v157
  v_and_b32 v146, v139, v158
  v_and_b32 v147, v139, v159
  s_waitcnt vmcnt(0)
  s_nop 0
  v_mfma_f32_16x16x32_bf16 v[148:151], v[144:147], v[116:119], v[148:151]
  s_branch L_wsk2
L_w2:
  s_branch L_w3
L_wsk2:
  s_mov_b32 s9, 0
L_wl_3:
  ds_read_b32 v16, v1 offset:4
  s_waitcnt lgkmcnt(0)
  v_readfirstlane_b32 s8, v16
  s_cmp_lg_u32 s8, 0
  s_cbranch_scc1 L_wld_4
  s_sleep 1
  s_add_u32 s9, s9, 1
  s_cmp_lt_u32 s9, 2097152
  s_cbranch_scc1 L_wl_3
L_wld_4:
  s_mov_b32 s88, s8
  s_bfe_u32 s80, s8, 524288
  s_sub_u32 s84, 0x80, s80
  s_bfe_u32 s81, s8, 524296
  s_sub_u32 s85, 0x80, s81
  s_bfe_u32 s82, s8, 524304
  s_sub_u32 s86, 0x80, s82
  s_bfe_u32 s83, s8, 524312
  s_sub_u32 s87, 0x80, s83
  s_mov_b32 s89, 0x0c0c0400
  s_mov_b32 s90, 0x04000c0c
  v_add_u32 v148, s84, v148
  v_add_u32 v149, s85, v149
  v_add_u32 v150, s86, v150
  v_add_u32 v151, s87, v151
  v_bfi_b32 v148, v14, s80, v148
  v_bfi_b32 v149, v14, s81, v149
  v_bfi_b32 v150, v14, s82, v150
  v_bfi_b32 v151, v14, s83, v151
  global_store_dwordx4 v12, v[148:151], s[36:37] sc1
  v_and_b32 v16, 1, v0
  v_lshlrev_b32 v16, 4, v16
  v_lshrrev_b32_e64 v36, v16, s88
  v_and_b32 v36, 0xffff, v36
  s_lshl_b32 s12, s4, 13
  s_lshl_b32 s13, s6, 9
  s_add_u32 s12, s12, s13
  s_add_u32 s12, s12, 4096
  v_lshlrev_b32 v12, 3, v0
  v_add_u32 v12, s12, v12
  v_mov_b32 v20, 0x80
  v_mov_b32 v21, 0x80
  v_mov_b32 v22, 0x80
  v_mov_b32 v23, 0x80
  v_mov_b32 v24, 0x80
  v_mov_b32 v25, 0x80
  v_mov_b32 v26, 0x80
  v_mov_b32 v27, 0x80
  v_mov_b32 v28, 0x80
  v_mov_b32 v29, 0x80
  v_mov_b32 v30, 0x80
  v_mov_b32 v31, 0x80
  v_mov_b32 v32, 0x80
  v_mov_b32 v33, 0x80
  v_mov_b32 v34, 0x80
  v_mov_b32 v35, 0x80
  s_mov_b32 s9, 0
L_tdl_5:
  s_memrealtime s[14:15]
  s_waitcnt lgkmcnt(0)
  s_sub_u32 s14, s14, s94
  s_cmp_ge_u32 s14, 550
  s_cbranch_scc1 L_tdd_6
  s_sleep 2
  s_add_u32 s9, s9, 1
  s_cmp_lt_u32 s9, 20000
  s_cbranch_scc1 L_tdl_5
L_tdd_6:
  s_mov_b64 s[64:65], -1
  s_mov_b64 s[66:67], -1
  s_mov_b64 s[68:69], -1
  s_mov_b64 s[70:71], -1
  s_mov_b64 s[72:73], -1
  s_mov_b64 s[74:75], -1
  s_mov_b64 s[76:77], -1
  s_mov_b64 s[78:79], -1
  s_mov_b32 s9, 0
L_tp_7:
  s_mov_b64 exec, s[64:65]
  global_load_dwordx2 v[20:21], v12, s[36:37] offset:-4096 sc1
  s_mov_b64 exec, s[66:67]
  global_load_dwordx2 v[22:23], v12, s[36:37] offset:-3072 sc1
  s_mov_b64 exec, s[68:69]
  global_load_dwordx2 v[24:25], v12, s[36:37] offset:-2048 sc1
  s_mov_b64 exec, s[70:71]
  global_load_dwordx2 v[26:27], v12, s[36:37] offset:-1024 sc1
  s_mov_b64 exec, s[72:73]
  global_load_dwordx2 v[28:29], v12, s[36:37] offset:0 sc1
  s_mov_b64 exec, s[74:75]
  global_load_dwordx2 v[30:31], v12, s[36:37] offset:1024 sc1
  s_mov_b64 exec, s[76:77]
  global_load_dwordx2 v[32:33], v12, s[36:37] offset:2048 sc1
  s_mov_b64 exec, s[78:79]
  global_load_dwordx2 v[34:35], v12, s[36:37] offset:3072 sc1
  s_mov_b64 exec, -1
  s_sleep 30
  v_perm_b32 v40, v21, v20, s89
  v_cmp_ne_u32_e64 s[64:65], v36, v40
  s_cmp_lg_u64 s[64:65], 0
  s_cselect_b64 s[64:65], -1, 0
  v_perm_b32 v40, v23, v22, s89
  v_cmp_ne_u32_e64 s[66:67], v36, v40
  s_cmp_lg_u64 s[66:67], 0
  s_cselect_b64 s[66:67], -1, 0
  v_perm_b32 v40, v25, v24, s89
  v_cmp_ne_u32_e64 s[68:69], v36, v40
  s_cmp_lg_u64 s[68:69], 0
  s_cselect_b64 s[68:69], -1, 0
  v_perm_b32 v40, v27, v26, s89
  v_cmp_ne_u32_e64 s[70:71], v36, v40
  s_cmp_lg_u64 s[70:71], 0
  s_cselect_b64 s[70:71], -1, 0
  v_perm_b32 v40, v29, v28, s89
  v_cmp_ne_u32_e64 s[72:73], v36, v40
  s_cmp_lg_u64 s[72:73], 0
  s_cselect_b64 s[72:73], -1, 0
  v_perm_b32 v40, v31, v30, s89
  v_cmp_ne_u32_e64 s[74:75], v36, v40
  s_cmp_lg_u64 s[74:75], 0
  s_cselect_b64 s[74:75], -1, 0
  v_perm_b32 v40, v33, v32, s89
  v_cmp_ne_u32_e64 s[76:77], v36, v40
  s_cmp_lg_u64 s[76:77], 0
  s_cselect_b64 s[76:77], -1, 0
  v_perm_b32 v40, v35, v34, s89
  v_cmp_ne_u32_e64 s[78:79], v36, v40
  s_cmp_lg_u64 s[78:79], 0
  s_cselect_b64 s[78:79], -1, 0
  s_or_b64 s[12:13], s[64:65], s[66:67]
  s_or_b64 s[12:13], s[12:13], s[68:69]
  s_or_b64 s[12:13], s[12:13], s[70:71]
  s_or_b64 s[12:13], s[12:13], s[72:73]
  s_or_b64 s[12:13], s[12:13], s[74:75]
  s_or_b64 s[12:13], s[12:13], s[76:77]
  s_or_b64 s[12:13], s[12:13], s[78:79]
  s_cbranch_scc0 L_tpd_8
  s_add_u32 s9, s9, 1
  s_cmp_lt_u32 s9, 131072
  s_cbranch_scc1 L_tp_7
L_tpd_8:
  v_add_f32 v42, v20, v22
  v_add_f32 v43, v21, v23
  v_add_f32 v42, v42, v24
  v_add_f32 v43, v43, v25
  v_add_f32 v42, v42, v26
  v_add_f32 v43, v43, v27
  v_add_f32 v42, v42, v28
  v_add_f32 v43, v43, v29
  v_add_f32 v42, v42, v30
  v_add_f32 v43, v43, v31
  v_add_f32 v42, v42, v32
  v_add_f32 v43, v43, v33
  v_add_f32 v42, v42, v34
  v_add_f32 v43, v43, v35
  v_cvt_pk_bf16_f32 v42, v42, v43
  v_lshlrev_b32 v13, 2, v0
  ds_write_b32 v13, v42 offset:256
  ds_write_b32 v1, v2 offset:0
  s_branch L_wsk3
L_w3:
  s_branch L_w4
L_wsk3:
  s_cmp_ge_u32 s5, 5
  s_cbranch_scc1 L_aux0_done
  s_lshl_b32 s12, s4, 9
  s_add_u32 s12, s12, 393216
  v_and_b32 v13, 31, v0
  v_lshl_add_u32 v13, v13, 4, s12
  s_and_b32 s91, s88, 0xffffff
  s_mov_b32 s92, 0x0c040100
  s_not_b32 s93, s88
  v_mov_b32 v44, 0x80
  v_mov_b32 v45, 0x80
  v_mov_b32 v46, 0x80
  v_mov_b32 v47, 0x80
  s_mov_b32 s9, 0
L_wl_9:
  ds_read_b128 v[16:19], v1 offset:80
  s_waitcnt lgkmcnt(0)
  v_and_b32 v16, v16, v17
  v_and_b32 v18, v18, v19
  v_and_b32 v16, v16, v18
  s_nop 0
  v_readfirstlane_b32 s8, v16
  s_cmp_lg_u32 s8, 0
  s_cbranch_scc1 L_wld_10
  s_sleep 4
  s_add_u32 s9, s9, 1
  s_cmp_lt_u32 s9, 2097152
  s_cbranch_scc1 L_wl_9
L_wld_10:
  s_mov_b32 s9, 0
L_tdl_11:
  s_memrealtime s[14:15]
  s_waitcnt lgkmcnt(0)
  s_sub_u32 s14, s14, s94
  s_cmp_ge_u32 s14, 1100
  s_cbranch_scc1 L_tdd_12
  s_sleep 2
  s_add_u32 s9, s9, 1
  s_cmp_lt_u32 s9, 20000
  s_cbranch_scc1 L_tdl_11
L_tdd_12:
  s_mov_b64 s[64:65], -1
  s_mov_b32 s9, 0
L_tp_13:
  s_mov_b64 exec, s[64:65]
  global_load_dwordx4 v[44:47], v13, s[36:37] sc1
  s_mov_b64 exec, -1
  s_sleep 20
  v_perm_b32 v48, v45, v44, s92
  v_xor_b32 v48, s91, v48
  v_xor_b32 v49, s88, v46
  v_xor_b32 v50, s93, v47
  v_or3_b32 v48, v48, v49, v50
  v_cmp_ne_u32_e64 s[64:65], 0, v48
  s_cmp_eq_u64 s[64:65], 0
  s_cbranch_scc1 L_tpd_14
  s_add_u32 s9, s9, 1
  s_cmp_lt_u32 s9, 131072
  s_cbranch_scc1 L_tp_13
L_tpd_14:
  v_and_b32 v20, 0xffff0000, v44
  v_mov_b32 v22, v20
  s_nop 1
  v_max_f32_dpp v22, v22, v22 row_ror:8 row_mask:0xf bank_mask:0xf
  s_nop 1
  v_max_f32_dpp v22, v22, v22 row_ror:4 row_mask:0xf bank_mask:0xf
  s_nop 1
  v_max_f32_dpp v22, v22, v22 row_ror:2 row_mask:0xf bank_mask:0xf
  s_nop 1
  v_max_f32_dpp v22, v22, v22 row_ror:1 row_mask:0xf bank_mask:0xf
  v_sub_f32 v23, v20, v22
  v_mul_f32 v23, 0x3fb8aa3b, v23
  v_exp_f32 v23, v23
  s_nop 0
  v_mul_f32 v23, v23, v45
  s_nop 1
  v_add_f32_dpp v23, v23, v23 row_ror:8 row_mask:0xf bank_mask:0xf
  s_nop 1
  v_add_f32_dpp v23, v23, v23 row_ror:4 row_mask:0xf bank_mask:0xf
  s_nop 1
  v_add_f32_dpp v23, v23, v23 row_ror:2 row_mask:0xf bank_mask:0xf
  s_nop 1
  v_add_f32_dpp v23, v23, v23 row_ror:1 row_mask:0xf bank_mask:0xf
  v_rcp_f32 v24, v23
  s_nop 0
  v_fma_f32 v25, -v23, v24, 1.0
  v_fmac_f32 v24, v25, v24
  v_mov_b32 v23, v24
  v_mov_b32 v26, v20
  s_nop 1
  v_max_f32_dpp v26, v26, v26 quad_perm:[1,0,3,2] row_mask:0xf bank_mask:0xf
  s_nop 1
  v_max_f32_dpp v26, v26, v26 quad_perm:[2,3,0,1] row_mask:0xf bank_mask:0xf
  v_sub_f32 v26, v26, v22
  v_mul_f32 v26, 0x3fb8aa3b, v26
  v_exp_f32 v26, v26
  v_bfe_u32 v27, v0, 2, 3
  v_lshlrev_b32 v27, 2, v27
  v_mul_f32 v26, v26, v24
  ds_write_b32 v27, v26 offset:128
  ds_write_b32 v1, v2 offset:28
L_aux0_done:
  s_endpgm
L_w4:
  s_branch L_w5
L_aux1:
  v_and_b32 v160, 1, v0
  v_lshlrev_b32 v160, 4, v160
  v_mov_b32 v161, 0xffff
  v_lshlrev_b32 v160, v160, v161
  v_bfe_u32 v161, v0, 1, 1
  v_cmp_eq_u32 vcc, 0, v161
  s_nop 1
  v_cndmask_b32 v156, 0, v160, vcc
  v_cmp_eq_u32 vcc, 1, v161
  s_nop 1
  v_cndmask_b32 v157, 0, v160, vcc
  v_bfe_u32 v11, v0, 2, 1
  v_lshl_add_u32 v11, v11, 2, v8
  v_mul_u32_u24 v11, 80, v11
  s_waitcnt lgkmcnt(0)
  ds_read_b128 v[120:123], v11 offset:1792
  ds_read_b128 v[124:127], v11 offset:1808
  ds_read_b128 v[128:131], v11 offset:1824
  ds_read_b128 v[132:135], v11 offset:1840
  ds_read_b128 v[136:139], v11 offset:1856
  v_lshlrev_b32 v12, 8, v8
  v_lshl_add_u32 v12, v9, 4, v12
  s_lshl_b32 s12, s11, 9
  s_add_u32 s12, s12, 262144
  v_add_u32 v12, s12, v12
  v_mov_b32 v14, 0xff
  s_waitcnt lgkmcnt(0)
  v_and_b32 v140, v120, v156
  v_and_b32 v141, v120, v157
  s_waitcnt vmcnt(19)
  s_nop 0
  v_mfma_f32_16x16x16_bf16 v[148:151], v[140:141], v[40:41], 0
  v_and_b32 v142, v121, v156
  v_and_b32 v143, v121, v157
  s_waitcnt vmcnt(18)
  s_nop 0
  v_mfma_f32_16x16x16_bf16 v[148:151], v[142:143], v[42:43], v[148:151]
  v_and_b32 v140, v122, v156
  v_and_b32 v141, v122, v157
  s_waitcnt vmcnt(17)
  s_nop 0
  v_mfma_f32_16x16x16_bf16 v[148:151], v[140:141], v[44:45], v[148:151]
  v_and_b32 v142, v123, v156
  v_and_b32 v143, v123, v157
  s_waitcnt vmcnt(16)
  s_nop 0
  v_mfma_f32_16x16x16_bf16 v[148:151], v[142:143], v[46:47], v[148:151]
  v_and_b32 v140, v124, v156
  v_and_b32 v141, v124, v157
  s_waitcnt vmcnt(15)
  s_nop 0
  v_mfma_f32_16x16x16_bf16 v[148:151], v[140:141], v[48:49], v[148:151]
  v_and_b32 v142, v125, v156
  v_and_b32 v143, v125, v157
  s_waitcnt vmcnt(14)
  s_nop 0
  v_mfma_f32_16x16x16_bf16 v[148:151], v[142:143], v[50:51], v[148:151]
  v_and_b32 v140, v126, v156
  v_and_b32 v141, v126, v157
  s_waitcnt vmcnt(13)
  s_nop 0
  v_mfma_f32_16x16x16_bf16 v[148:151], v[140:141], v[52:53], v[148:151]
  v_and_b32 v142, v127, v156
  v_and_b32 v143, v127, v157
  s_waitcnt vmcnt(12)
  s_nop 0
  v_mfma_f32_16x16x16_bf16 v[148:151], v[142:143], v[54:55], v[148:151]
  v_and_b32 v140, v128, v156
  v_and_b32 v141, v128, v157
  s_waitcnt vmcnt(11)
  s_nop 0
  v_mfma_f32_16x16x16_bf16 v[148:151], v[140:141], v[56:57], v[148:151]
  v_and_b32 v142, v129, v156
  v_and_b32 v143, v129, v157
  s_waitcnt vmcnt(10)
  s_nop 0
  v_mfma_f32_16x16x16_bf16 v[148:151], v[142:143], v[58:59], v[148:151]
  v_and_b32 v140, v130, v156
  v_and_b32 v141, v130, v157
  s_waitcnt vmcnt(9)
  s_nop 0
  v_mfma_f32_16x16x16_bf16 v[148:151], v[140:141], v[60:61], v[148:151]
  v_and_b32 v142, v131, v156
  v_and_b32 v143, v131, v157
  s_waitcnt vmcnt(8)
  s_nop 0
  v_mfma_f32_16x16x16_bf16 v[148:151], v[142:143], v[62:63], v[148:151]
  v_and_b32 v140, v132, v156
  v_and_b32 v141, v132, v157
  s_waitcnt vmcnt(7)
  s_nop 0
  v_mfma_f32_16x16x16_bf16 v[148:151], v[140:141], v[64:65], v[148:151]
  v_and_b32 v142, v133, v156
  v_and_b32 v143, v133, v157
  s_waitcnt vmcnt(6)
  s_nop 0
  v_mfma_f32_16x16x16_bf16 v[148:151], v[142:143], v[66:67], v[148:151]
  v_and_b32 v140, v134, v156
  v_and_b32 v141, v134, v157
  s_waitcnt vmcnt(5)
  s_nop 0
  v_mfma_f32_16x16x16_bf16 v[148:151], v[140:141], v[68:69], v[148:151]
  v_and_b32 v142, v135, v156
  v_and_b32 v143, v135, v157
  s_waitcnt vmcnt(4)
  s_nop 0
  v_mfma_f32_16x16x16_bf16 v[148:151], v[142:143], v[70:71], v[148:151]
  v_and_b32 v140, v136, v156
  v_and_b32 v141, v136, v157
  s_waitcnt vmcnt(3)
  s_nop 0
  v_mfma_f32_16x16x16_bf16 v[148:151], v[140:141], v[72:73], v[148:151]
  v_and_b32 v142, v137, v156
  v_and_b32 v143, v137, v157
  s_waitcnt vmcnt(2)
  s_nop 0
  v_mfma_f32_16x16x16_bf16 v[148:151], v[142:143], v[74:75], v[148:151]
  v_and_b32 v140, v138, v156
  v_and_b32 v141, v138, v157
  s_waitcnt vmcnt(1)
  s_nop 0
  v_mfma_f32_16x16x16_bf16 v[148:151], v[140:141], v[76:77], v[148:151]
  v_and_b32 v142, v139, v156
  v_and_b32 v143, v139, v157
  s_waitcnt vmcnt(0)
  s_nop 0
  v_mfma_f32_16x16x16_bf16 v[148:151], v[142:143], v[78:79], v[148:151]
  s_branch L_wsk5
L_w5:
  s_branch L_w6
L_wsk5:
  s_mov_b32 s9, 0
L_wl_15:
  ds_read_b32 v16, v1 offset:4
  s_waitcnt lgkmcnt(0)
  v_readfirstlane_b32 s8, v16
  s_cmp_lg_u32 s8, 0
  s_cbranch_scc1 L_wld_16
  s_sleep 1
  s_add_u32 s9, s9, 1
  s_cmp_lt_u32 s9, 2097152
  s_cbranch_scc1 L_wl_15
L_wld_16:
  s_mov_b32 s88, s8
  s_bfe_u32 s80, s8, 524288
  s_sub_u32 s84, 0x80, s80
  s_bfe_u32 s81, s8, 524296
  s_sub_u32 s85, 0x80, s81
  s_bfe_u32 s82, s8, 524304
  s_sub_u32 s86, 0x80, s82
  s_bfe_u32 s83, s8, 524312
  s_sub_u32 s87, 0x80, s83
  s_mov_b32 s89, 0x0c0c0400
  s_mov_b32 s90, 0x04000c0c
  v_add_u32 v148, s84, v148
  v_add_u32 v149, s85, v149
  v_add_u32 v150, s86, v150
  v_add_u32 v151, s87, v151
  v_bfi_b32 v148, v14, s80, v148
  v_bfi_b32 v149, v14, s81, v149
  v_bfi_b32 v150, v14, s82, v150
  v_bfi_b32 v151, v14, s83, v151
  s_mov_b64 exec, 0xffffffff
  global_store_dwordx4 v12, v[148:151], s[36:37] sc1
  s_mov_b64 exec, -1
  v_and_b32 v16, 1, v0
  v_lshlrev_b32 v16, 4, v16
  v_lshrrev_b32_e64 v36, v16, s88
  v_and_b32 v36, 0xffff, v36
  s_cmp_lt_u32 s5, 5
  s_cbranch_scc1 L_aux1_done
  s_lshl_b32 s12, s4, 12
  s_add_u32 s12, s12, 262144
  v_lshlrev_b32 v12, 3, v0
  v_add_u32 v12, s12, v12
  v_mov_b32 v20, 0x80
  v_mov_b32 v21, 0x80
  v_mov_b32 v22, 0x80
  v_mov_b32 v23, 0x80
  v_mov_b32 v24, 0x80
  v_mov_b32 v25, 0x80
  v_mov_b32 v26, 0x80
  v_mov_b32 v27, 0x80
  v_mov_b32 v28, 0x80
  v_mov_b32 v29, 0x80
  v_mov_b32 v30, 0x80
  v_mov_b32 v31, 0x80
  v_mov_b32 v32, 0x80
  v_mov_b32 v33, 0x80
  v_mov_b32 v34, 0x80
  v_mov_b32 v35, 0x80
  s_mov_b32 s9, 0
L_tdl_17:
  s_memrealtime s[14:15]
  s_waitcnt lgkmcnt(0)
  s_sub_u32 s14, s14, s94
  s_cmp_ge_u32 s14, 650
  s_cbranch_scc1 L_tdd_18
  s_sleep 2
  s_add_u32 s9, s9, 1
  s_cmp_lt_u32 s9, 20000
  s_cbranch_scc1 L_tdl_17
L_tdd_18:
  s_mov_b64 s[64:65], -1
  s_mov_b64 s[66:67], -1
  s_mov_b64 s[68:69], -1
  s_mov_b64 s[70:71], -1
  s_mov_b64 s[72:73], -1
  s_mov_b64 s[74:75], -1
  s_mov_b64 s[76:77], -1
  s_mov_b64 s[78:79], -1
  s_mov_b32 s9, 0
L_tp_19:
  s_mov_b64 exec, s[64:65]
  global_load_dwordx2 v[20:21], v12, s[36:37] offset:0 sc1
  s_mov_b64 exec, s[66:67]
  global_load_dwordx2 v[22:23], v12, s[36:37] offset:512 sc1
  s_mov_b64 exec, s[68:69]
  global_load_dwordx2 v[24:25], v12, s[36:37] offset:1024 sc1
  s_mov_b64 exec, s[70:71]
  global_load_dwordx2 v[26:27], v12, s[36:37] offset:1536 sc1
  s_mov_b64 exec, s[72:73]
  global_load_dwordx2 v[28:29], v12, s[36:37] offset:2048 sc1
  s_mov_b64 exec, s[74:75]
  global_load_dwordx2 v[30:31], v12, s[36:37] offset:2560 sc1
  s_mov_b64 exec, s[76:77]
  global_load_dwordx2 v[32:33], v12, s[36:37] offset:3072 sc1
  s_mov_b64 exec, s[78:79]
  global_load_dwordx2 v[34:35], v12, s[36:37] offset:3584 sc1
  s_mov_b64 exec, -1
  s_sleep 40
  v_perm_b32 v40, v21, v20, s89
  v_cmp_ne_u32_e64 s[64:65], v36, v40
  s_cmp_lg_u64 s[64:65], 0
  s_cselect_b64 s[64:65], -1, 0
  v_perm_b32 v40, v23, v22, s89
  v_cmp_ne_u32_e64 s[66:67], v36, v40
  s_cmp_lg_u64 s[66:67], 0
  s_cselect_b64 s[66:67], -1, 0
  v_perm_b32 v40, v25, v24, s89
  v_cmp_ne_u32_e64 s[68:69], v36, v40
  s_cmp_lg_u64 s[68:69], 0
  s_cselect_b64 s[68:69], -1, 0
  v_perm_b32 v40, v27, v26, s89
  v_cmp_ne_u32_e64 s[70:71], v36, v40
  s_cmp_lg_u64 s[70:71], 0
  s_cselect_b64 s[70:71], -1, 0
  v_perm_b32 v40, v29, v28, s89
  v_cmp_ne_u32_e64 s[72:73], v36, v40
  s_cmp_lg_u64 s[72:73], 0
  s_cselect_b64 s[72:73], -1, 0
  v_perm_b32 v40, v31, v30, s89
  v_cmp_ne_u32_e64 s[74:75], v36, v40
  s_cmp_lg_u64 s[74:75], 0
  s_cselect_b64 s[74:75], -1, 0
  v_perm_b32 v40, v33, v32, s89
  v_cmp_ne_u32_e64 s[76:77], v36, v40
  s_cmp_lg_u64 s[76:77], 0
  s_cselect_b64 s[76:77], -1, 0
  v_perm_b32 v40, v35, v34, s89
  v_cmp_ne_u32_e64 s[78:79], v36, v40
  s_cmp_lg_u64 s[78:79], 0
  s_cselect_b64 s[78:79], -1, 0
  s_or_b64 s[12:13], s[64:65], s[66:67]
  s_or_b64 s[12:13], s[12:13], s[68:69]
  s_or_b64 s[12:13], s[12:13], s[70:71]
  s_or_b64 s[12:13], s[12:13], s[72:73]
  s_or_b64 s[12:13], s[12:13], s[74:75]
  s_or_b64 s[12:13], s[12:13], s[76:77]
  s_or_b64 s[12:13], s[12:13], s[78:79]
  s_cbranch_scc0 L_tpd_20
  s_add_u32 s9, s9, 1
  s_cmp_lt_u32 s9, 131072
  s_cbranch_scc1 L_tp_19
L_tpd_20:
  v_add_f32 v42, v20, v22
  v_add_f32 v43, v21, v23
  v_add_f32 v42, v42, v24
  v_add_f32 v43, v43, v25
  v_add_f32 v42, v42, v26
  v_add_f32 v43, v43, v27
  v_add_f32 v42, v42, v28
  v_add_f32 v43, v43, v29
  v_add_f32 v42, v42, v30
  v_add_f32 v43, v43, v31
  v_add_f32 v42, v42, v32
  v_add_f32 v43, v43, v33
  v_add_f32 v42, v42, v34
  v_add_f32 v43, v43, v35
  v_max_f32 v42, 0, v42
  v_max_f32 v43, 0, v43
  v_cvt_pk_bf16_f32 v42, v42, v43
  v_lshlrev_b32 v13, 2, v0
  ds_write_b32 v13, v42 offset:512
  ds_write_b32 v1, v2 offset:12
L_aux1_done:
  s_endpgm
L_w6:
  s_branch L_w7
L_aux2:
  s_cmp_eq_u32 s11, 0
  s_cbranch_scc0 L_a2_poll
  s_memrealtime s[12:13]
  s_waitcnt lgkmcnt(0)
  v_mov_b32 v17, s12
  s_mul_i32 s12, s12, 0x9e3779b1
  s_and_b32 s12, s12, 0x7f7f7f7f
  s_max_u32 s12, s12, 1
  v_mov_b32 v16, s12
  s_mov_b64 exec, 1
  global_store_dwordx2 v1, v[16:17], s[34:35] sc1
  s_mov_b64 exec, -1
  ds_write_b32 v1, v16 offset:4
  s_branch L_a2_done
L_a2_poll:
  s_sleep 20
  s_waitcnt lgkmcnt(0)
  s_mov_b32 s9, 0
L_fl_21:
  global_load_dwordx2 v[16:17], v1, s[34:35] sc1
  s_waitcnt vmcnt(0)
  v_readfirstlane_b32 s12, v16
  v_readfirstlane_b32 s13, v17
  s_cmp_eq_u32 s12, 0
  s_cbranch_scc1 L_flr_23
  s_cmp_ge_u32 s9, 64
  s_cbranch_scc1 L_fld_22
  s_sub_u32 s13, s94, s13
  s_cmp_lt_i32 s13, 800
  s_cbranch_scc0 L_flr_23
  s_cmp_gt_i32 s13, -100000
  s_cbranch_scc1 L_fld_22
L_flr_23:
  s_sleep 4
  s_add_u32 s9, s9, 1
  s_cmp_lt_u32 s9, 131072
  s_cbranch_scc1 L_fl_21
L_fld_22:
  ds_write_b32 v1, v16 offset:4
L_a2_done:
  s_endpgm
L_w7:
  s_branch L_w8
L_aux3:
  s_waitcnt vmcnt(0)
  s_branch L_w0
L_wdone:
  s_waitcnt lgkmcnt(0)
  s_cmp_ge_u32 s5, 5
  s_cbranch_scc1 L_aux3_done
  s_bitcmp1_b32 s4, 0
  s_cbranch_scc1 L_aux3_done
  s_lshr_b32 s14, s4, 1
  s_mul_i32 s14, s14, 5
  s_add_u32 s14, s14, s5
  v_and_b32 v3, 3, v0
  v_lshrrev_b32 v4, 1, v3
  v_mul_u32_u24 v5, 640, v4
  v_and_b32 v4, 1, v3
  v_lshl_add_u32 v5, v4, 2, v5
  v_lshrrev_b32 v4, 4, v0
  v_add_u32 v5, v5, v4
  s_lshl_b32 s8, s14, 3
  v_add_u32 v5, s8, v5
  v_lshlrev_b32 v5, 1, v5
  global_load_ushort v6, v5, s[16:17]
  v_lshrrev_b32 v7, 2, v0
  v_mul_u32_u24 v8, 5120, v7
  v_lshl_add_u32 v8, v3, 4, v8
  s_lshl_b32 s8, s14, 6
  s_add_u32 s15, s8, 753664
  v_add_u32 v9, s15, v8
  v_add_u32 v10, 81920, v9
  v_add_u32 v11, 163840, v9
  v_add_u32 v12, 245760, v9
  s_add_u32 s15, s8, 589824
  v_add_u32 v13, s15, v8
  v_add_u32 v14, 81920, v13
  s_mov_b32 s9, 0
L_wl_24:
  ds_read_b32 v16, v1 offset:4
  s_waitcnt lgkmcnt(0)
  v_readfirstlane_b32 s8, v16
  s_cmp_lg_u32 s8, 0
  s_cbranch_scc1 L_wld_25
  s_sleep 1
  s_add_u32 s9, s9, 1
  s_cmp_lt_u32 s9, 2097152
  s_cbranch_scc1 L_wl_24
L_wld_25:
  s_mov_b32 s88, s8
  s_bfe_u32 s80, s8, 524288
  s_sub_u32 s84, 0x80, s80
  s_bfe_u32 s81, s8, 524296
  s_sub_u32 s85, 0x80, s81
  s_bfe_u32 s82, s8, 524304
  s_sub_u32 s86, 0x80, s82
  s_bfe_u32 s83, s8, 524312
  s_sub_u32 s87, 0x80, s83
  s_mov_b32 s89, 0x0c0c0400
  s_mov_b32 s90, 0x04000c0c
  v_mov_b32 v16, 0x80
  v_mov_b32 v17, 0x80
  v_mov_b32 v18, 0x80
  v_mov_b32 v19, 0x80
  v_mov_b32 v20, 0x80
  v_mov_b32 v21, 0x80
  v_mov_b32 v22, 0x80
  v_mov_b32 v23, 0x80
  v_mov_b32 v24, 0x80
  v_mov_b32 v25, 0x80
  v_mov_b32 v26, 0x80
  v_mov_b32 v27, 0x80
  v_mov_b32 v28, 0x80
  v_mov_b32 v29, 0x80
  v_mov_b32 v30, 0x80
  v_mov_b32 v31, 0x80
  v_mov_b32 v32, 0x80
  v_mov_b32 v33, 0x80
  v_mov_b32 v34, 0x80
  v_mov_b32 v35, 0x80
  v_mov_b32 v36, 0x80
  v_mov_b32 v37, 0x80
  v_mov_b32 v38, 0x80
  v_mov_b32 v39, 0x80
  s_mov_b32 exec_lo, 0xff000000
  s_mov_b32 exec_hi, -1
  v_mov_b32 v28, s80
  v_mov_b32 v29, s81
  v_mov_b32 v30, s82
  v_mov_b32 v31, s83
  s_mov_b64 exec, -1
  s_branch L_wsk8
L_w8:
  s_branch L_w9
L_wsk8:
  s_mov_b32 s9, 0
L_wc_26:
  ds_read_b32 v44, v1 offset:16
  s_waitcnt lgkmcnt(0)
  v_readfirstlane_b32 s8, v44
  s_cmp_ge_u32 s8, 4
  s_cbranch_scc1 L_wcd_27
  s_sleep 8
  s_add_u32 s9, s9, 1
  s_cmp_lt_u32 s9, 2097152
  s_cbranch_scc1 L_wc_26
L_wcd_27:
  s_mov_b32 s9, 0
L_tdl_28:
  s_memrealtime s[14:15]
  s_waitcnt lgkmcnt(0)
  s_sub_u32 s14, s14, s94
  s_cmp_ge_u32 s14, 1380
  s_cbranch_scc1 L_tdd_29
  s_sleep 2
  s_add_u32 s9, s9, 1
  s_cmp_lt_u32 s9, 20000
  s_cbranch_scc1 L_tdl_28
L_tdd_29:
  s_mov_b64 s[64:65], -1
  s_mov_b64 s[66:67], -1
  s_mov_b64 s[68:69], -1
  s_mov_b64 s[70:71], 16777215
  s_mov_b64 s[72:73], -1
  s_mov_b64 s[74:75], -1
  s_mov_b32 s76, 0
  s_mov_b32 s9, 0
L_up_30:
  s_mov_b64 exec, s[64:65]
  global_load_dwordx4 v[16:19], v9, s[36:37] sc1
  s_mov_b64 exec, s[66:67]
  global_load_dwordx4 v[20:23], v10, s[36:37] sc1
  s_mov_b64 exec, s[68:69]
  global_load_dwordx4 v[24:27], v11, s[36:37] sc1
  s_mov_b64 exec, s[70:71]
  global_load_dwordx4 v[28:31], v12, s[36:37] sc1
  s_mov_b64 exec, -1
  s_cmp_eq_u32 s76, 0
  s_cbranch_scc0 L_upe_32
  ds_read_b32 v44, v1 offset:24
  s_sleep 12
  s_waitcnt lgkmcnt(0)
  v_readfirstlane_b32 s76, v44
  s_branch L_upc_33
L_upe_32:
  s_mov_b64 exec, s[72:73]
  global_load_dwordx4 v[32:35], v13, s[36:37] sc1
  s_mov_b64 exec, s[74:75]
  global_load_dwordx4 v[36:39], v14, s[36:37] sc1
  s_mov_b64 exec, -1
  s_sleep 5
  v_perm_b32 v44, v33, v32, s89
  v_perm_b32 v45, v35, v34, s90
  v_or_b32 v44, v44, v45
  v_xor_b32 v44, s88, v44
  s_nop 1
  v_or_b32_dpp v44, v44, v44 quad_perm:[1,0,3,2] row_mask:0xf bank_mask:0xf
  s_nop 1
  v_or_b32_dpp v44, v44, v44 quad_perm:[2,3,0,1] row_mask:0xf bank_mask:0xf
  v_cmp_ne_u32_e64 s[72:73], 0, v44
  v_perm_b32 v44, v37, v36, s89
  v_perm_b32 v45, v39, v38, s90
  v_or_b32 v44, v44, v45
  v_xor_b32 v44, s88, v44
  s_nop 1
  v_or_b32_dpp v44, v44, v44 quad_perm:[1,0,3,2] row_mask:0xf bank_mask:0xf
  s_nop 1
  v_or_b32_dpp v44, v44, v44 quad_perm:[2,3,0,1] row_mask:0xf bank_mask:0xf
  v_cmp_ne_u32_e64 s[74:75], 0, v44
L_upc_33:
  v_perm_b32 v44, v17, v16, s89
  v_perm_b32 v45, v19, v18, s90
  v_or_b32 v44, v44, v45
  v_xor_b32 v44, s88, v44
  s_nop 1
  v_or_b32_dpp v44, v44, v44 quad_perm:[1,0,3,2] row_mask:0xf bank_mask:0xf
  s_nop 1
  v_or_b32_dpp v44, v44, v44 quad_perm:[2,3,0,1] row_mask:0xf bank_mask:0xf
  v_cmp_ne_u32_e64 s[64:65], 0, v44
  v_perm_b32 v44, v21, v20, s89
  v_perm_b32 v45, v23, v22, s90
  v_or_b32 v44, v44, v45
  v_xor_b32 v44, s88, v44
  s_nop 1
  v_or_b32_dpp v44, v44, v44 quad_perm:[1,0,3,2] row_mask:0xf bank_mask:0xf
  s_nop 1
  v_or_b32_dpp v44, v44, v44 quad_perm:[2,3,0,1] row_mask:0xf bank_mask:0xf
  v_cmp_ne_u32_e64 s[66:67], 0, v44
  v_perm_b32 v44, v25, v24, s89
  v_perm_b32 v45, v27, v26, s90
  v_or_b32 v44, v44, v45
  v_xor_b32 v44, s88, v44
  s_nop 1
  v_or_b32_dpp v44, v44, v44 quad_perm:[1,0,3,2] row_mask:0xf bank_mask:0xf
  s_nop 1
  v_or_b32_dpp v44, v44, v44 quad_perm:[2,3,0,1] row_mask:0xf bank_mask:0xf
  v_cmp_ne_u32_e64 s[68:69], 0, v44
  v_perm_b32 v44, v29, v28, s89
  v_perm_b32 v45, v31, v30, s90
  v_or_b32 v44, v44, v45
  v_xor_b32 v44, s88, v44
  s_nop 1
  v_or_b32_dpp v44, v44, v44 quad_perm:[1,0,3,2] row_mask:0xf bank_mask:0xf
  s_nop 1
  v_or_b32_dpp v44, v44, v44 quad_perm:[2,3,0,1] row_mask:0xf bank_mask:0xf
  v_cmp_ne_u32_e64 s[70:71], 0, v44
  s_or_b64 s[12:13], s[64:65], s[66:67]
  s_or_b64 s[12:13], s[12:13], s[68:69]
  s_or_b64 s[12:13], s[12:13], s[70:71]
  s_cbranch_scc0 L_upd_31
  s_add_u32 s9, s9, 1
  s_cmp_lt_u32 s9, 131072
  s_cbranch_scc1 L_up_30
L_upd_31:
  v_add_f32 v48, v16, v20
  v_add_f32 v52, v24, v28
  v_add_f32 v49, v17, v21
  v_add_f32 v53, v25, v29
  v_add_f32 v50, v18, v22
  v_add_f32 v54, v26, v30
  v_add_f32 v51, v19, v23
  v_add_f32 v55, v27, v31
  v_add_f32 v48, v48, v52
  v_add_f32 v49, v49, v53
  v_add_f32 v50, v50, v54
  v_add_f32 v51, v51, v55
  s_nop 0
  v_permlane32_swap_b32 v48, v50
  v_permlane32_swap_b32 v49, v51
  v_add_f32 v48, v48, v50
  v_add_f32 v49, v49, v51
  s_nop 1
  v_permlane16_swap_b32 v48, v49
  v_add_f32 v48, v48, v49
  s_nop 1
  v_add_f32_dpp v48, v48, v48 row_ror:8 row_mask:0xf bank_mask:0xf
  s_nop 1
  v_add_f32_dpp v48, v48, v48 row_ror:4 row_mask:0xf bank_mask:0xf
  v_cvt_pk_bf16_f32 v48, v48, v48
  v_lshlrev_b32 v48, 16, v48
  v_mul_f32 v49, 0xbfb8aa3b, v48
  v_exp_f32 v49, v49
  s_nop 0
  v_add_f32 v49, 1.0, v49
  v_rcp_f32 v50, v49
  s_nop 0
  v_mul_f32 v51, v48, v50
  v_fma_f32 v52, -v51, v49, v48
  v_fmac_f32 v51, v52, v50
  v_cvt_pk_bf16_f32 v51, v51, v51
  v_lshlrev_b32 v51, 16, v51
  v_lshlrev_b32 v6, 16, v6
  s_mov_b32 s9, 0
L_wl_34:
  ds_read_b32 v44, v1 offset:24
  s_waitcnt lgkmcnt(0)
  v_readfirstlane_b32 s8, v44
  s_cmp_lg_u32 s8, 0
  s_cbranch_scc1 L_wld_35
  s_sleep 1
  s_add_u32 s9, s9, 1
  s_cmp_lt_u32 s9, 2097152
  s_cbranch_scc1 L_wl_34
L_wld_35:
  s_or_b64 s[12:13], s[72:73], s[74:75]
  s_cbranch_scc0 L_tpd_37
  s_mov_b32 s9, 0
L_tp_36:
  s_mov_b64 exec, s[72:73]
  global_load_dwordx4 v[32:35], v13, s[36:37] sc1
  s_mov_b64 exec, s[74:75]
  global_load_dwordx4 v[36:39], v14, s[36:37] sc1
  s_mov_b64 exec, -1
  s_sleep 5
  v_perm_b32 v44, v33, v32, s89
  v_perm_b32 v45, v35, v34, s90
  v_or_b32 v44, v44, v45
  v_xor_b32 v44, s88, v44
  s_nop 1
  v_or_b32_dpp v44, v44, v44 quad_perm:[1,0,3,2] row_mask:0xf bank_mask:0xf
  s_nop 1
  v_or_b32_dpp v44, v44, v44 quad_perm:[2,3,0,1] row_mask:0xf bank_mask:0xf
  v_cmp_ne_u32_e64 s[72:73], 0, v44
  v_perm_b32 v44, v37, v36, s89
  v_perm_b32 v45, v39, v38, s90
  v_or_b32 v44, v44, v45
  v_xor_b32 v44, s88, v44
  s_nop 1
  v_or_b32_dpp v44, v44, v44 quad_perm:[1,0,3,2] row_mask:0xf bank_mask:0xf
  s_nop 1
  v_or_b32_dpp v44, v44, v44 quad_perm:[2,3,0,1] row_mask:0xf bank_mask:0xf
  v_cmp_ne_u32_e64 s[74:75], 0, v44
  s_or_b64 s[12:13], s[72:73], s[74:75]
  s_cbranch_scc0 L_tpd_37
  s_add_u32 s9, s9, 1
  s_cmp_lt_u32 s9, 131072
  s_cbranch_scc1 L_tp_36
L_tpd_37:
  v_add_f32 v56, v32, v36
  v_add_f32 v57, v33, v37
  v_add_f32 v58, v34, v38
  v_add_f32 v59, v35, v39
  s_nop 0
  v_permlane32_swap_b32 v56, v58
  v_permlane32_swap_b32 v57, v59
  v_add_f32 v56, v56, v58
  v_add_f32 v57, v57, v59
  s_nop 1
  v_permlane16_swap_b32 v56, v57
  v_add_f32 v56, v56, v57
  s_nop 1
  v_add_f32_dpp v56, v56, v56 row_ror:8 row_mask:0xf bank_mask:0xf
  s_nop 1
  v_add_f32_dpp v56, v56, v56 row_ror:4 row_mask:0xf bank_mask:0xf
  v_cvt_pk_bf16_f32 v56, v56, v56
  v_lshlrev_b32 v56, 16, v56
  v_mul_f32 v56, v56, v51
  v_cvt_pk_bf16_f32 v56, v56, v56
  v_lshlrev_b32 v56, 16, v56
  v_add_f32 v56, v6, v56
  v_cvt_pk_bf16_f32 v56, v56, v56
  s_mov_b32 exec_lo, 0x000f000f
  s_mov_b32 exec_hi, 0x000f000f
  global_store_short v5, v56, s[32:33] sc1
  s_mov_b64 exec, -1
L_aux3_done:
  s_endpgm
L_w9:
  s_branch L_w10
L_kwave:
  v_and_b32 v4, 15, v0
  v_lshlrev_b32 v5, 4, v4
  s_lshl_b32 s14, s11, 6
  s_lshl_b32 s15, s10, 4
  s_add_u32 s14, s14, s15
  s_add_u32 s14, s14, 393216
  v_mov_b32 v12, s14
  v_bfrev_b32 v11, v4
  v_lshrrev_b32 v11, 26, v11
  v_lshrrev_b32 v13, 4, v0
  v_lshl_add_u32 v11, v13, 7, v11
  s_lshl_b32 s14, s10, 9
  v_add_u32 v11, s14, v11
  v_and_b32 v6, 2, v0
  v_cmp_ne_u32 s[48:49], 0, v6
  v_and_b32 v6, 1, v0
  v_cmp_ne_u32 s[50:51], 0, v6
  v_mov_b32 v14, 0xff
  s_mov_b32 s9, 0
L_wl_38:
  ds_read_b32 v6, v1 offset:4
  s_waitcnt lgkmcnt(0)
  v_readfirstlane_b32 s8, v6
  s_cmp_lg_u32 s8, 0
  s_cbranch_scc1 L_wld_39
  s_sleep 1
  s_add_u32 s9, s9, 1
  s_cmp_lt_u32 s9, 2097152
  s_cbranch_scc1 L_wl_38
L_wld_39:
  s_mov_b32 s88, s8
  s_bfe_u32 s80, s8, 524288
  s_sub_u32 s84, 0x80, s80
  s_bfe_u32 s81, s8, 524296
  s_sub_u32 s85, 0x80, s81
  s_bfe_u32 s82, s8, 524304
  s_sub_u32 s86, 0x80, s82
  s_bfe_u32 s83, s8, 524312
  s_sub_u32 s87, 0x80, s83
  s_mov_b32 s89, 0x0c0c0400
  s_mov_b32 s90, 0x04000c0c
  s_mov_b32 s9, 0
L_wl_40:
  ds_read_b32 v6, v1 offset:0
  s_waitcnt lgkmcnt(0)
  v_readfirstlane_b32 s8, v6
  s_cmp_lg_u32 s8, 0
  s_cbranch_scc1 L_wld_41
  s_sleep 1
  s_add_u32 s9, s9, 1
  s_cmp_lt_u32 s9, 2097152
  s_cbranch_scc1 L_wl_40
L_wld_41:
  ds_read_b128 v[144:147], v5 offset:256
  s_waitcnt lgkmcnt(0)
  s_waitcnt vmcnt(28)
  v_dot2_f32_bf16 v16, v16, v144, 0
  v_dot2_f32_bf16 v20, v20, v144, 0
  v_dot2_f32_bf16 v24, v24, v144, 0
  v_dot2_f32_bf16 v28, v28, v144, 0
  v_dot2_f32_bf16 v16, v17, v145, v16
  v_dot2_f32_bf16 v20, v21, v145, v20
  v_dot2_f32_bf16 v24, v25, v145, v24
  v_dot2_f32_bf16 v28, v29, v145, v28
  v_dot2_f32_bf16 v16, v18, v146, v16
  v_dot2_f32_bf16 v20, v22, v146, v20
  v_dot2_f32_bf16 v24, v26, v146, v24
  v_dot2_f32_bf16 v28, v30, v146, v28
  v_dot2_f32_bf16 v16, v19, v147, v16
  v_dot2_f32_bf16 v20, v23, v147, v20
  v_dot2_f32_bf16 v24, v27, v147, v24
  v_dot2_f32_bf16 v28, v31, v147, v28
  v_add_f32_dpp v16, v16, v16 row_ror:8 row_mask:0xf bank_mask:0x3
  s_nop 1
  v_add_f32_dpp v16, v20, v20 row_ror:8 row_mask:0xf bank_mask:0xc
  v_add_f32_dpp v24, v24, v24 row_ror:8 row_mask:0xf bank_mask:0x3
  s_nop 1
  v_add_f32_dpp v24, v28, v28 row_ror:8 row_mask:0xf bank_mask:0xc
  v_add_f32_dpp v16, v16, v16 row_half_mirror row_mask:0xf bank_mask:0x5
  s_nop 1
  v_add_f32_dpp v16, v24, v24 row_half_mirror row_mask:0xf bank_mask:0xa
  s_waitcnt vmcnt(24)
  v_dot2_f32_bf16 v32, v32, v144, 0
  v_dot2_f32_bf16 v36, v36, v144, 0
  v_dot2_f32_bf16 v40, v40, v144, 0
  v_dot2_f32_bf16 v44, v44, v144, 0
  v_dot2_f32_bf16 v32, v33, v145, v32
  v_dot2_f32_bf16 v36, v37, v145, v36
  v_dot2_f32_bf16 v40, v41, v145, v40
  v_dot2_f32_bf16 v44, v45, v145, v44
  v_dot2_f32_bf16 v32, v34, v146, v32
  v_dot2_f32_bf16 v36, v38, v146, v36
  v_dot2_f32_bf16 v40, v42, v146, v40
  v_dot2_f32_bf16 v44, v46, v146, v44
  v_dot2_f32_bf16 v32, v35, v147, v32
  v_dot2_f32_bf16 v36, v39, v147, v36
  v_dot2_f32_bf16 v40, v43, v147, v40
  v_dot2_f32_bf16 v44, v47, v147, v44
  v_add_f32_dpp v32, v32, v32 row_ror:8 row_mask:0xf bank_mask:0x3
  s_nop 1
  v_add_f32_dpp v32, v36, v36 row_ror:8 row_mask:0xf bank_mask:0xc
  v_add_f32_dpp v40, v40, v40 row_ror:8 row_mask:0xf bank_mask:0x3
  s_nop 1
  v_add_f32_dpp v40, v44, v44 row_ror:8 row_mask:0xf bank_mask:0xc
  v_add_f32_dpp v32, v32, v32 row_half_mirror row_mask:0xf bank_mask:0x5
  s_nop 1
  v_add_f32_dpp v32, v40, v40 row_half_mirror row_mask:0xf bank_mask:0xa
  s_waitcnt vmcnt(20)
  v_dot2_f32_bf16 v48, v48, v144, 0
  v_dot2_f32_bf16 v52, v52, v144, 0
  v_dot2_f32_bf16 v56, v56, v144, 0
  v_dot2_f32_bf16 v60, v60, v144, 0
  v_dot2_f32_bf16 v48, v49, v145, v48
  v_dot2_f32_bf16 v52, v53, v145, v52
  v_dot2_f32_bf16 v56, v57, v145, v56
  v_dot2_f32_bf16 v60, v61, v145, v60
  v_dot2_f32_bf16 v48, v50, v146, v48
  v_dot2_f32_bf16 v52, v54, v146, v52
  v_dot2_f32_bf16 v56, v58, v146, v56
  v_dot2_f32_bf16 v60, v62, v146, v60
  v_dot2_f32_bf16 v48, v51, v147, v48
  v_dot2_f32_bf16 v52, v55, v147, v52
  v_dot2_f32_bf16 v56, v59, v147, v56
  v_dot2_f32_bf16 v60, v63, v147, v60
  v_add_f32_dpp v48, v48, v48 row_ror:8 row_mask:0xf bank_mask:0x3
  s_nop 1
  v_add_f32_dpp v48, v52, v52 row_ror:8 row_mask:0xf bank_mask:0xc
  v_add_f32_dpp v56, v56, v56 row_ror:8 row_mask:0xf bank_mask:0x3
  s_nop 1
  v_add_f32_dpp v56, v60, v60 row_ror:8 row_mask:0xf bank_mask:0xc
  v_add_f32_dpp v48, v48, v48 row_half_mirror row_mask:0xf bank_mask:0x5
  s_nop 1
  v_add_f32_dpp v48, v56, v56 row_half_mirror row_mask:0xf bank_mask:0xa
  s_branch L_wsk10
L_w10:
  s_branch L_w11
L_wsk10:
  s_waitcnt vmcnt(16)
  v_dot2_f32_bf16 v64, v64, v144, 0
  v_dot2_f32_bf16 v68, v68, v144, 0
  v_dot2_f32_bf16 v72, v72, v144, 0
  v_dot2_f32_bf16 v76, v76, v144, 0
  v_dot2_f32_bf16 v64, v65, v145, v64
  v_dot2_f32_bf16 v68, v69, v145, v68
  v_dot2_f32_bf16 v72, v73, v145, v72
  v_dot2_f32_bf16 v76, v77, v145, v76
  v_dot2_f32_bf16 v64, v66, v146, v64
  v_dot2_f32_bf16 v68, v70, v146, v68
  v_dot2_f32_bf16 v72, v74, v146, v72
  v_dot2_f32_bf16 v76, v78, v146, v76
  v_dot2_f32_bf16 v64, v67, v147, v64
  v_dot2_f32_bf16 v68, v71, v147, v68
  v_dot2_f32_bf16 v72, v75, v147, v72
  v_dot2_f32_bf16 v76, v79, v147, v76
  v_add_f32_dpp v64, v64, v64 row_ror:8 row_mask:0xf bank_mask:0x3
  s_nop 1
  v_add_f32_dpp v64, v68, v68 row_ror:8 row_mask:0xf bank_mask:0xc
  v_add_f32_dpp v72, v72, v72 row_ror:8 row_mask:0xf bank_mask:0x3
  s_nop 1
  v_add_f32_dpp v72, v76, v76 row_ror:8 row_mask:0xf bank_mask:0xc
  v_add_f32_dpp v64, v64, v64 row_half_mirror row_mask:0xf bank_mask:0x5
  s_nop 1
  v_add_f32_dpp v64, v72, v72 row_half_mirror row_mask:0xf bank_mask:0xa
  s_waitcnt vmcnt(12)
  v_dot2_f32_bf16 v80, v80, v144, 0
  v_dot2_f32_bf16 v84, v84, v144, 0
  v_dot2_f32_bf16 v88, v88, v144, 0
  v_dot2_f32_bf16 v92, v92, v144, 0
  v_dot2_f32_bf16 v80, v81, v145, v80
  v_dot2_f32_bf16 v84, v85, v145, v84
  v_dot2_f32_bf16 v88, v89, v145, v88
  v_dot2_f32_bf16 v92, v93, v145, v92
  v_dot2_f32_bf16 v80, v82, v146, v80
  v_dot2_f32_bf16 v84, v86, v146, v84
  v_dot2_f32_bf16 v88, v90, v146, v88
  v_dot2_f32_bf16 v92, v94, v146, v92
  v_dot2_f32_bf16 v80, v83, v147, v80
  v_dot2_f32_bf16 v84, v87, v147, v84
  v_dot2_f32_bf16 v88, v91, v147, v88
  v_dot2_f32_bf16 v92, v95, v147, v92
  v_add_f32_dpp v80, v80, v80 row_ror:8 row_mask:0xf bank_mask:0x3
  s_nop 1
  v_add_f32_dpp v80, v84, v84 row_ror:8 row_mask:0xf bank_mask:0xc
  v_add_f32_dpp v88, v88, v88 row_ror:8 row_mask:0xf bank_mask:0x3
  s_nop 1
  v_add_f32_dpp v88, v92, v92 row_ror:8 row_mask:0xf bank_mask:0xc
  v_add_f32_dpp v80, v80, v80 row_half_mirror row_mask:0xf bank_mask:0x5
  s_nop 1
  v_add_f32_dpp v80, v88, v88 row_half_mirror row_mask:0xf bank_mask:0xa
  s_waitcnt vmcnt(8)
  v_dot2_f32_bf16 v96, v96, v144, 0
  v_dot2_f32_bf16 v100, v100, v144, 0
  v_dot2_f32_bf16 v104, v104, v144, 0
  v_dot2_f32_bf16 v108, v108, v144, 0
  v_dot2_f32_bf16 v96, v97, v145, v96
  v_dot2_f32_bf16 v100, v101, v145, v100
  v_dot2_f32_bf16 v104, v105, v145, v104
  v_dot2_f32_bf16 v108, v109, v145, v108
  v_dot2_f32_bf16 v96, v98, v146, v96
  v_dot2_f32_bf16 v100, v102, v146, v100
  v_dot2_f32_bf16 v104, v106, v146, v104
  v_dot2_f32_bf16 v108, v110, v146, v108
  v_dot2_f32_bf16 v96, v99, v147, v96
  v_dot2_f32_bf16 v100, v103, v147, v100
  v_dot2_f32_bf16 v104, v107, v147, v104
  v_dot2_f32_bf16 v108, v111, v147, v108
  v_add_f32_dpp v96, v96, v96 row_ror:8 row_mask:0xf bank_mask:0x3
  s_nop 1
  v_add_f32_dpp v96, v100, v100 row_ror:8 row_mask:0xf bank_mask:0xc
  v_add_f32_dpp v104, v104, v104 row_ror:8 row_mask:0xf bank_mask:0x3
  s_nop 1
  v_add_f32_dpp v104, v108, v108 row_ror:8 row_mask:0xf bank_mask:0xc
  v_add_f32_dpp v96, v96, v96 row_half_mirror row_mask:0xf bank_mask:0x5
  s_nop 1
  v_add_f32_dpp v96, v104, v104 row_half_mirror row_mask:0xf bank_mask:0xa
  s_waitcnt vmcnt(4)
  v_dot2_f32_bf16 v112, v112, v144, 0
  v_dot2_f32_bf16 v116, v116, v144, 0
  v_dot2_f32_bf16 v120, v120, v144, 0
  v_dot2_f32_bf16 v124, v124, v144, 0
  v_dot2_f32_bf16 v112, v113, v145, v112
  v_dot2_f32_bf16 v116, v117, v145, v116
  v_dot2_f32_bf16 v120, v121, v145, v120
  v_dot2_f32_bf16 v124, v125, v145, v124
  v_dot2_f32_bf16 v112, v114, v146, v112
  v_dot2_f32_bf16 v116, v118, v146, v116
  v_dot2_f32_bf16 v120, v122, v146, v120
  v_dot2_f32_bf16 v124, v126, v146, v124
  v_dot2_f32_bf16 v112, v115, v147, v112
  v_dot2_f32_bf16 v116, v119, v147, v116
  v_dot2_f32_bf16 v120, v123, v147, v120
  v_dot2_f32_bf16 v124, v127, v147, v124
  v_add_f32_dpp v112, v112, v112 row_ror:8 row_mask:0xf bank_mask:0x3
  s_nop 1
  v_add_f32_dpp v112, v116, v116 row_ror:8 row_mask:0xf bank_mask:0xc
  v_add_f32_dpp v120, v120, v120 row_ror:8 row_mask:0xf bank_mask:0x3
  s_nop 1
  v_add_f32_dpp v120, v124, v124 row_ror:8 row_mask:0xf bank_mask:0xc
  v_add_f32_dpp v112, v112, v112 row_half_mirror row_mask:0xf bank_mask:0x5
  s_nop 1
  v_add_f32_dpp v112, v120, v120 row_half_mirror row_mask:0xf bank_mask:0xa
  s_branch L_wsk11
L_w11:
  s_branch L_w12
L_wsk11:
  s_waitcnt vmcnt(0)
  v_dot2_f32_bf16 v128, v128, v144, 0
  v_dot2_f32_bf16 v132, v132, v144, 0
  v_dot2_f32_bf16 v136, v136, v144, 0
  v_dot2_f32_bf16 v140, v140, v144, 0
  v_dot2_f32_bf16 v128, v129, v145, v128
  v_dot2_f32_bf16 v132, v133, v145, v132
  v_dot2_f32_bf16 v136, v137, v145, v136
  v_dot2_f32_bf16 v140, v141, v145, v140
  v_dot2_f32_bf16 v128, v130, v146, v128
  v_dot2_f32_bf16 v132, v134, v146, v132
  v_dot2_f32_bf16 v136, v138, v146, v136
  v_dot2_f32_bf16 v140, v142, v146, v140
  v_dot2_f32_bf16 v128, v131, v147, v128
  v_dot2_f32_bf16 v132, v135, v147, v132
  v_dot2_f32_bf16 v136, v139, v147, v136
  v_dot2_f32_bf16 v140, v143, v147, v140
  v_add_f32_dpp v128, v128, v128 row_ror:8 row_mask:0xf bank_mask:0x3
  s_nop 1
  v_add_f32_dpp v128, v132, v132 row_ror:8 row_mask:0xf bank_mask:0xc
  v_add_f32_dpp v136, v136, v136 row_ror:8 row_mask:0xf bank_mask:0x3
  s_nop 1
  v_add_f32_dpp v136, v140, v140 row_ror:8 row_mask:0xf bank_mask:0xc
  v_add_f32_dpp v128, v128, v128 row_half_mirror row_mask:0xf bank_mask:0x5
  s_nop 1
  v_add_f32_dpp v128, v136, v136 row_half_mirror row_mask:0xf bank_mask:0xa
  v_cndmask_b32 v17, v16, v32, s[48:49]
  v_cndmask_b32 v18, v32, v16, s[48:49]
  v_cndmask_b32 v49, v48, v64, s[48:49]
  v_cndmask_b32 v50, v64, v48, s[48:49]
  v_cndmask_b32 v81, v80, v96, s[48:49]
  v_cndmask_b32 v82, v96, v80, s[48:49]
  v_cndmask_b32 v113, v112, v128, s[48:49]
  v_cndmask_b32 v114, v128, v112, s[48:49]
  v_add_f32_dpp v16, v18, v17 quad_perm:[2,3,0,1] row_mask:0xf bank_mask:0xf
  v_add_f32_dpp v48, v50, v49 quad_perm:[2,3,0,1] row_mask:0xf bank_mask:0xf
  v_add_f32_dpp v80, v82, v81 quad_perm:[2,3,0,1] row_mask:0xf bank_mask:0xf
  v_add_f32_dpp v112, v114, v113 quad_perm:[2,3,0,1] row_mask:0xf bank_mask:0xf
  v_cndmask_b32 v17, v16, v48, s[50:51]
  v_cndmask_b32 v18, v48, v16, s[50:51]
  v_cndmask_b32 v81, v80, v112, s[50:51]
  v_cndmask_b32 v82, v112, v80, s[50:51]
  v_add_f32_dpp v16, v18, v17 quad_perm:[1,0,3,2] row_mask:0xf bank_mask:0xf
  s_nop 0
  v_add_f32_dpp v80, v82, v81 quad_perm:[1,0,3,2] row_mask:0xf bank_mask:0xf
  v_cvt_pk_bf16_f32 v6, v16, v80
  v_lshlrev_b32 v7, 16, v6
  v_and_b32 v8, 0xffff0000, v6
  v_mul_f32 v7, 0x3db504f3, v7
  v_mul_f32 v8, 0x3db504f3, v8
  v_cvt_pk_bf16_f32 v6, v7, v8
  v_lshlrev_b32 v148, 16, v6
  v_and_b32 v149, 0xffff0000, v6
  v_max_f32 v150, v148, v149
  s_nop 1
  v_max_f32_dpp v150, v150, v150 row_ror:8 row_mask:0xf bank_mask:0xf
  s_nop 1
  v_max_f32_dpp v150, v150, v150 row_ror:4 row_mask:0xf bank_mask:0xf
  s_nop 1
  v_max_f32_dpp v150, v150, v150 row_ror:2 row_mask:0xf bank_mask:0xf
  s_nop 1
  v_max_f32_dpp v150, v150, v150 row_ror:1 row_mask:0xf bank_mask:0xf
  v_mov_b32 v10, v150
  s_nop 1
  v_permlane16_swap_b32 v150, v10
  v_max_f32 v150, v150, v10
  v_mov_b32 v10, v150
  s_nop 1
  v_permlane32_swap_b32 v150, v10
  v_max_f32 v150, v150, v10
  v_sub_f32 v7, v148, v150
  v_sub_f32 v8, v149, v150
  v_mul_f32 v7, 0x3fb8aa3b, v7
  v_mul_f32 v8, 0x3fb8aa3b, v8
  v_exp_f32 v7, v7
  v_exp_f32 v8, v8
  s_lshl_b32 s12, s10, 2
  v_mov_b32 v13, s12
  v_cvt_pk_bf16_f32 v152, v7, v7
  v_cvt_pk_bf16_f32 v153, v8, v8
  ds_write_b32 v11, v152 offset:2560
  ds_write_b32 v11, v153 offset:2624
  ds_write_b32 v13, v150 offset:112
  ds_write_b32 v13, v2 offset:32
  v_add_f32 v151, v7, v8
  s_nop 1
  v_add_f32_dpp v151, v151, v151 row_ror:8 row_mask:0xf bank_mask:0xf
  s_nop 1
  v_add_f32_dpp v151, v151, v151 row_ror:4 row_mask:0xf bank_mask:0xf
  s_nop 1
  v_add_f32_dpp v151, v151, v151 row_ror:2 row_mask:0xf bank_mask:0xf
  s_nop 1
  v_add_f32_dpp v151, v151, v151 row_ror:1 row_mask:0xf bank_mask:0xf
  v_mov_b32 v10, v151
  s_nop 1
  v_permlane16_swap_b32 v151, v10
  v_add_f32 v151, v151, v10
  v_mov_b32 v10, v151
  s_nop 1
  v_permlane32_swap_b32 v151, v10
  v_add_f32 v151, v151, v10
  s_and_b32 s8, s88, 0xffff
  v_or_b32 v150, s8, v150
  v_add_u32 v151, s86, v151
  v_bfi_b32 v151, v14, s82, v151
  v_mov_b32 v152, s88
  v_not_b32 v153, v152
  s_mov_b64 exec, 1
  global_store_dwordx4 v12, v[150:153], s[36:37] sc1
  s_mov_b64 exec, -1
  s_lshl_b32 s12, s10, 2
  v_mov_b32 v13, s12
  ds_write_b32 v13, v2 offset:80
  s_branch L_wsk12
L_w12:
  s_branch L_w13
L_wsk12:
L_ktile:
  s_lshl_b32 s14, s5, 2
  s_add_u32 s14, s14, s10
  s_sub_u32 s75, s14, 20
  s_cmp_lt_u32 s14, 20
  s_cselect_b32 s75, s14, s75
  s_cselect_b32 s76, 2, 1
  s_cselect_b32 s72, 1, 2
  s_mov_b32 s70, 753664
  s_cselect_b32 s70, 589824, s70
  s_lshr_b32 s73, s75, s76
  s_lshl_b32 s74, s73, s76
  s_sub_u32 s74, s75, s74
  s_lshl_b32 s75, s4, s76
  s_add_u32 s75, s75, s74
  s_mul_i32 s71, s75, 32*1280
  s_cmp_lt_u32 s14, 20
  s_cselect_b32 s75, s4, s75
  s_mul_i32 s75, s75, 5120
  s_add_u32 s70, s70, s75
  s_lshl_b32 s75, s73, 10
  s_add_u32 s70, s70, s75
  s_lshl_b32 s75, s73, 8
  s_add_u32 s71, s71, s75
  s_cmp_ge_u32 s73, 5
  s_cselect_b32 s75, 0, 2
  s_cmp_ge_u32 s4, 27
  s_cselect_b32 s75, 0, s75
  s_cmp_eq_u32 s72, 2
  s_cselect_b32 s72, s75, s72
  v_lshrrev_b32 v8, 4, v0
  v_and_b32 v9, 15, v0
  v_mul_u32_u24 v10, 8*1280, v8
  v_lshl_add_u32 v10, v9, 4, v10
  v_and_b32 v13, 15, v0
  v_lshrrev_b32 v12, 4, v0
  v_lshlrev_b32 v12, 4, v12
  v_lshl_add_u32 v12, v13, 6, v12
  v_add_u32 v12, s70, v12
  s_cmp_eq_u32 s72, 1
  s_cselect_b32 s44, s24, s30
  s_cselect_b32 s45, s25, s31
  s_and_b32 s45, s45, 0xffff
  s_mov_b32 s47, 2211840
  s_cselect_b32 s46, 5242880, s47
  s_mov_b32 s47, 0x20000
  s_add_u32 s13, s71, 5120
  s_cmp_eq_u32 s72, 0
  s_cbranch_scc1 L_k_done
  s_cmp_eq_u32 s72, 2
  s_cbranch_scc1 L_tg_42
  s_mov_b32 s9, 0
L_wl_44:
  ds_read_b128 v[144:147], v1 offset:64
  s_waitcnt lgkmcnt(0)
  v_and_b32 v144, v144, v145
  v_and_b32 v146, v146, v147
  v_and_b32 v144, v144, v146
  s_nop 0
  v_readfirstlane_b32 s8, v144
  s_cmp_lg_u32 s8, 0
  s_cbranch_scc1 L_wld_45
  s_sleep 2
  s_add_u32 s9, s9, 1
  s_cmp_lt_u32 s9, 2097152
  s_cbranch_scc1 L_wl_44
L_wld_45:
  s_mov_b32 s9, 0
L_tgl_46:
  s_memrealtime s[14:15]
  s_waitcnt lgkmcnt(0)
  s_sub_u32 s14, s14, s94
  s_cmp_ge_u32 s14, 1070
  s_cbranch_scc1 L_tgd_47
  s_sleep 2
  s_add_u32 s9, s9, 1
  s_cmp_lt_u32 s9, 20000
  s_cbranch_scc1 L_tgl_46
L_tgd_47:
  s_branch L_tg2_43
L_tg_42:
  s_mov_b32 s9, 0
L_wl_48:
  ds_read_b128 v[144:147], v1 offset:64
  s_waitcnt lgkmcnt(0)
  v_and_b32 v144, v144, v145
  v_and_b32 v146, v146, v147
  v_and_b32 v144, v144, v146
  s_nop 0
  v_readfirstlane_b32 s8, v144
  s_cmp_lg_u32 s8, 0
  s_cbranch_scc1 L_wld_49
  s_sleep 2
  s_add_u32 s9, s9, 1
  s_cmp_lt_u32 s9, 2097152
  s_cbranch_scc1 L_wl_48
L_wld_49:
  s_mov_b32 s9, 0
L_tgl_50:
  s_memrealtime s[14:15]
  s_waitcnt lgkmcnt(0)
  s_sub_u32 s14, s14, s94
  s_cmp_ge_u32 s14, 1170
  s_cbranch_scc1 L_tgd_51
  s_sleep 2
  s_add_u32 s9, s9, 1
  s_cmp_lt_u32 s9, 20000
  s_cbranch_scc1 L_tgl_50
L_tgd_51:
L_tg2_43:
  buffer_load_dwordx4 v[16:19], v10, s[44:47], s71 offen offset:0 nt
  buffer_load_dwordx4 v[20:23], v10, s[44:47], s71 offen offset:1280 nt
  buffer_load_dwordx4 v[24:27], v10, s[44:47], s71 offen offset:2560 nt
  buffer_load_dwordx4 v[28:31], v10, s[44:47], s71 offen offset:3840 nt
  buffer_load_dwordx4 v[32:35], v10, s[44:47], s13 offen offset:0 nt
  buffer_load_dwordx4 v[36:39], v10, s[44:47], s13 offen offset:1280 nt
  buffer_load_dwordx4 v[40:43], v10, s[44:47], s13 offen offset:2560 nt
  buffer_load_dwordx4 v[44:47], v10, s[44:47], s13 offen offset:3840 nt
  v_and_b32 v3, 3, v0
  v_lshlrev_b32 v3, 9, v3
  v_bfe_u32 v4, v0, 3, 1
  v_lshl_add_u32 v3, v4, 11, v3
  v_bfe_u32 v4, v0, 2, 1
  v_lshl_add_u32 v3, v4, 4, v3
  v_lshl_add_u32 v3, v8, 5, v3
  s_lshl_b32 s14, s4, 12
  s_lshl_b32 s15, s74, 7
  s_add_u32 s14, s14, s15
  s_add_u32 s14, s14, 409600
  v_add_u32 v3, s14, v3
  v_bfe_u32 v4, v0, 3, 1
  v_lshlrev_b32 v4, 7, v4
  v_lshl_add_u32 v4, v8, 4, v4
  s_lshl_b32 s14, s74, 6
  v_add_u32 v4, s14, v4
  v_bfe_u32 v5, v0, 4, 1
  v_cmp_eq_u32 s[48:49], 0, v5
  v_bfe_u32 v5, v0, 2, 1
  v_cmp_eq_u32 s[52:53], 0, v5
  s_mov_b32 s14, 0x05040100
  s_mov_b32 s15, 0x07060302
  s_waitcnt vmcnt(0)
  v_perm_b32 v48, v20, v16, s14
  v_perm_b32 v52, v20, v16, s15
  v_perm_b32 v49, v28, v24, s14
  v_perm_b32 v53, v28, v24, s15
  v_perm_b32 v50, v36, v32, s14
  v_perm_b32 v54, v36, v32, s15
  v_perm_b32 v51, v44, v40, s14
  v_perm_b32 v55, v44, v40, s15
  v_perm_b32 v56, v21, v17, s14
  v_perm_b32 v60, v21, v17, s15
  v_perm_b32 v57, v29, v25, s14
  v_perm_b32 v61, v29, v25, s15
  v_perm_b32 v58, v37, v33, s14
  v_perm_b32 v62, v37, v33, s15
  v_perm_b32 v59, v45, v41, s14
  v_perm_b32 v63, v45, v41, s15
  v_perm_b32 v64, v22, v18, s14
  v_perm_b32 v68, v22, v18, s15
  v_perm_b32 v65, v30, v26, s14
  v_perm_b32 v69, v30, v26, s15
  v_perm_b32 v66, v38, v34, s14
  v_perm_b32 v70, v38, v34, s15
  v_perm_b32 v67, v46, v42, s14
  v_perm_b32 v71, v46, v42, s15
  v_perm_b32 v72, v23, v19, s14
  v_perm_b32 v76, v23, v19, s15
  v_perm_b32 v73, v31, v27, s14
  v_perm_b32 v77, v31, v27, s15
  v_perm_b32 v74, v39, v35, s14
  v_perm_b32 v78, v39, v35, s15
  v_perm_b32 v75, v47, v43, s14
  v_perm_b32 v79, v47, v43, s15
  s_branch L_wsk13
L_w13:
  s_branch L_w14
L_wsk13:
  s_cmp_eq_u32 s72, 1
  s_cbranch_scc1 L_t_wo
  s_mov_b32 s9, 0
L_wl_52:
  ds_read_b32 v144, v1 offset:12
  s_waitcnt lgkmcnt(0)
  v_readfirstlane_b32 s8, v144
  s_cmp_lg_u32 s8, 0
  s_cbranch_scc1 L_wld_53
  s_sleep 2
  s_add_u32 s9, s9, 1
  s_cmp_lt_u32 s9, 2097152
  s_cbranch_scc1 L_wl_52
L_wld_53:
  ds_read_b128 v[112:115], v4 offset:512
  s_waitcnt lgkmcnt(0)
  s_branch L_t_mm
L_t_wo:
  v_mov_b32 v88, 0x80
  v_mov_b32 v89, 0x80
  v_mov_b32 v90, 0x80
  v_mov_b32 v91, 0x80
  v_bfe_u32 v86, v0, 3, 1
  v_and_b32 v87, 3, v0
  v_lshl_add_u32 v86, v86, 2, v87
  v_lshlrev_b32 v86, 2, v86
  s_mov_b32 s9, 0
L_wl_54:
  ds_read_b32 v84, v1 offset:28
  s_waitcnt lgkmcnt(0)
  v_readfirstlane_b32 s8, v84
  s_cmp_lg_u32 s8, 0
  s_cbranch_scc1 L_wld_55
  s_sleep 2
  s_add_u32 s9, s9, 1
  s_cmp_lt_u32 s9, 2097152
  s_cbranch_scc1 L_wl_54
L_wld_55:
  ds_read_b32 v92, v86 offset:128
  s_mov_b32 s9, 0
L_wc_56:
  ds_read_b32 v84, v1 offset:16
  s_waitcnt lgkmcnt(0)
  v_readfirstlane_b32 s8, v84
  s_cmp_ge_u32 s8, 4
  s_cbranch_scc1 L_wcd_57
  s_sleep 2
  s_add_u32 s9, s9, 1
  s_cmp_lt_u32 s9, 2097152
  s_cbranch_scc1 L_wc_56
L_wcd_57:
  s_mov_b32 s9, 0
L_tdl_58:
  s_memrealtime s[14:15]
  s_waitcnt lgkmcnt(0)
  s_sub_u32 s14, s14, s94
  s_cmp_ge_u32 s14, 1220
  s_cbranch_scc1 L_tdd_59
  s_sleep 2
  s_add_u32 s9, s9, 1
  s_cmp_lt_u32 s9, 20000
  s_cbranch_scc1 L_tdl_58
L_tdd_59:
  s_mov_b64 s[54:55], -1
  s_mov_b32 s9, 0
L_tp_60:
  s_mov_b64 exec, s[54:55]
  global_load_dwordx4 v[88:91], v3, s[36:37] sc1
  s_mov_b64 exec, -1
  s_sleep 6
  v_perm_b32 v84, v89, v88, s89
  v_perm_b32 v85, v91, v90, s90
  v_or_b32 v84, v84, v85
  v_cmp_ne_u32_e64 s[54:55], s88, v84
  s_cmp_lg_u64 s[54:55], 0
  s_cselect_b64 s[54:55], -1, 0
  s_cmp_eq_u64 s[54:55], 0
  s_cbranch_scc1 L_tpd_61
  s_add_u32 s9, s9, 1
  s_cmp_lt_u32 s9, 131072
  s_cbranch_scc1 L_tp_60
L_tpd_61:
  v_mul_f32 v93, v88, v92
  v_mul_f32 v94, v89, v92
  v_mul_f32 v95, v90, v92
  v_mul_f32 v96, v91, v92
  v_add_f32_dpp v80, v93, v93 quad_perm:[1,0,3,2] row_mask:0xf bank_mask:0xf
  v_add_f32_dpp v81, v94, v94 quad_perm:[1,0,3,2] row_mask:0xf bank_mask:0xf
  v_add_f32_dpp v82, v95, v95 quad_perm:[1,0,3,2] row_mask:0xf bank_mask:0xf
  v_add_f32_dpp v83, v96, v96 quad_perm:[1,0,3,2] row_mask:0xf bank_mask:0xf
  v_add_f32_dpp v80, v80, v80 quad_perm:[2,3,0,1] row_mask:0xf bank_mask:0xf
  v_add_f32_dpp v81, v81, v81 quad_perm:[2,3,0,1] row_mask:0xf bank_mask:0xf
  v_add_f32_dpp v82, v82, v82 quad_perm:[2,3,0,1] row_mask:0xf bank_mask:0xf
  v_add_f32_dpp v83, v83, v83 quad_perm:[2,3,0,1] row_mask:0xf bank_mask:0xf
  v_cvt_pk_bf16_f32 v112, v80, v81
  v_cvt_pk_bf16_f32 v113, v82, v83
  v_mov_b32 v114, v112
  v_mov_b32 v115, v113
  v_mov_b32_dpp v84, v112 row_half_mirror row_mask:0xf bank_mask:0xf
  v_mov_b32_dpp v85, v113 row_half_mirror row_mask:0xf bank_mask:0xf
  v_cndmask_b32 v112, v84, v112, s[52:53]
  v_cndmask_b32 v113, v85, v113, s[52:53]
  v_cndmask_b32 v114, v114, v84, s[52:53]
  v_cndmask_b32 v115, v115, v85, s[52:53]
L_t_mm:
  s_nop 1
  v_mfma_f32_16x16x32_bf16 v[116:119], v[112:115], v[48:51], 0
  v_mfma_f32_16x16x32_bf16 v[120:123], v[112:115], v[52:55], 0
  v_mfma_f32_16x16x32_bf16 v[124:127], v[112:115], v[56:59], 0
  v_mfma_f32_16x16x32_bf16 v[128:131], v[112:115], v[60:63], 0
  v_mfma_f32_16x16x32_bf16 v[132:135], v[112:115], v[64:67], 0
  v_mfma_f32_16x16x32_bf16 v[136:139], v[112:115], v[68:71], 0
  v_mfma_f32_16x16x32_bf16 v[140:143], v[112:115], v[72:75], 0
  v_mfma_f32_16x16x32_bf16 v[144:147], v[112:115], v[76:79], 0
  s_nop 4
  v_cndmask_b32 v80, v132, v116, s[48:49]
  v_cndmask_b32 v81, v136, v120, s[48:49]
  v_cndmask_b32 v82, v140, v124, s[48:49]
  v_cndmask_b32 v83, v144, v128, s[48:49]
  s_cmp_eq_u32 s72, 1
  s_cbranch_scc0 L_t_pub
  v_lshlrev_b32 v4, 4, v0
  s_lshl_b32 s12, s10, 10
  v_add_u32 v5, s12, v4
  ds_write_b128 v5, v[80:83] offset:6656
  s_mov_b64 exec, 1
  ds_add_rtn_u32 v6, v1, v2 offset:20
  s_mov_b64 exec, -1
  s_waitcnt lgkmcnt(0)
  v_readfirstlane_b32 s8, v6
  s_cmp_eq_u32 s8, 3
  s_cbranch_scc0 L_k_done
  ds_read_b128 v[96:99], v4 offset:6656
  ds_read_b128 v[100:103], v4 offset:7680
  ds_read_b128 v[104:107], v4 offset:8704
  ds_read_b128 v[108:111], v4 offset:9728
  s_waitcnt lgkmcnt(0)
  v_add_f32 v96, v96, v100
  v_add_f32 v104, v104, v108
  v_add_f32 v97, v97, v101
  v_add_f32 v105, v105, v109
  v_add_f32 v98, v98, v102
  v_add_f32 v106, v106, v110
  v_add_f32 v99, v99, v103
  v_add_f32 v107, v107, v111
  v_add_f32 v80, v96, v104
  v_add_f32 v81, v97, v105
  v_add_f32 v82, v98, v106
  v_add_f32 v83, v99, v107
  v_add_u32 v80, s84, v80
  v_add_u32 v81, s85, v81
  v_add_u32 v82, s86, v82
  v_add_u32 v83, s87, v83
  v_bfi_b32 v80, v14, s80, v80
  v_bfi_b32 v81, v14, s81, v81
  v_bfi_b32 v82, v14, s82, v82
  v_bfi_b32 v83, v14, s83, v83
  global_store_dwordx4 v12, v[80:83], s[36:37] sc1
  ds_write_b32 v1, v2 offset:24
  s_branch L_k_done
L_t_pub:
  v_add_u32 v80, s84, v80
  v_add_u32 v81, s85, v81
  v_add_u32 v82, s86, v82
  v_add_u32 v83, s87, v83
  v_bfi_b32 v80, v14, s80, v80
  v_bfi_b32 v81, v14, s81, v81
  v_bfi_b32 v82, v14, s82, v82
  v_bfi_b32 v83, v14, s83, v83
  global_store_dwordx4 v12, v[80:83], s[36:37] sc1
L_k_done:
  s_endpgm
L_w14:
  s_branch L_w15
L_vissue:
  s_add_u32 s44, s12, s45
  buffer_load_dwordx4 v[16:19], v3, s[40:43], s44 offen nt
  s_add_u32 s45, s45, 1024
  s_and_b32 s45, s45, 0x7fff
  s_add_u32 s44, s12, s45
  buffer_load_dwordx4 v[20:23], v3, s[40:43], s44 offen nt
  s_add_u32 s45, s45, 1024
  s_and_b32 s45, s45, 0x7fff
  s_add_u32 s44, s12, s45
  buffer_load_dwordx4 v[24:27], v3, s[40:43], s44 offen nt
  s_add_u32 s45, s45, 1024
  s_and_b32 s45, s45, 0x7fff
  s_add_u32 s44, s12, s45
  buffer_load_dwordx4 v[28:31], v3, s[40:43], s44 offen nt
  s_add_u32 s45, s45, 1024
  s_and_b32 s45, s45, 0x7fff
  s_add_u32 s44, s12, s45
  buffer_load_dwordx4 v[32:35], v3, s[40:43], s44 offen nt
  s_add_u32 s45, s45, 1024
  s_and_b32 s45, s45, 0x7fff
  s_add_u32 s44, s12, s45
  buffer_load_dwordx4 v[36:39], v3, s[40:43], s44 offen nt
  s_add_u32 s45, s45, 1024
  s_and_b32 s45, s45, 0x7fff
  s_add_u32 s44, s12, s45
  buffer_load_dwordx4 v[40:43], v3, s[40:43], s44 offen nt
  s_add_u32 s45, s45, 1024
  s_and_b32 s45, s45, 0x7fff
  s_add_u32 s44, s12, s45
  buffer_load_dwordx4 v[44:47], v3, s[40:43], s44 offen nt
  s_add_u32 s45, s45, 1024
  s_and_b32 s45, s45, 0x7fff
  s_memrealtime s[14:15]
  s_waitcnt vmcnt(7)
  s_waitcnt lgkmcnt(0)
  s_sub_u32 s14, s14, s94
  s_cmp_ge_u32 s14, 950
  s_cbranch_scc1 L_fast8
  s_add_u32 s44, s12, s45
  buffer_load_dwordx4 v[48:51], v3, s[40:43], s44 offen nt
  s_add_u32 s45, s45, 1024
  s_and_b32 s45, s45, 0x7fff
  s_waitcnt vmcnt(7)
  s_add_u32 s44, s12, s45
  buffer_load_dwordx4 v[52:55], v3, s[40:43], s44 offen nt
  s_add_u32 s45, s45, 1024
  s_and_b32 s45, s45, 0x7fff
  s_memrealtime s[14:15]
  s_waitcnt vmcnt(7)
  s_waitcnt lgkmcnt(0)
  s_sub_u32 s14, s14, s94
  s_cmp_ge_u32 s14, 950
  s_cbranch_scc1 L_fast10
  s_add_u32 s44, s12, s45
  buffer_load_dwordx4 v[56:59], v3, s[40:43], s44 offen nt
  s_add_u32 s45, s45, 1024
  s_and_b32 s45, s45, 0x7fff
  s_waitcnt vmcnt(7)
  s_add_u32 s44, s12, s45
  buffer_load_dwordx4 v[60:63], v3, s[40:43], s44 offen nt
  s_add_u32 s45, s45, 1024
  s_and_b32 s45, s45, 0x7fff
  s_memrealtime s[14:15]
  s_waitcnt vmcnt(7)
  s_waitcnt lgkmcnt(0)
  s_sub_u32 s14, s14, s94
  s_cmp_ge_u32 s14, 950
  s_cbranch_scc1 L_fast12
  s_add_u32 s44, s12, s45
  buffer_load_dwordx4 v[64:67], v3, s[40:43], s44 offen nt
  s_add_u32 s45, s45, 1024
  s_and_b32 s45, s45, 0x7fff
  s_waitcnt vmcnt(7)
  s_add_u32 s44, s12, s45
  buffer_load_dwordx4 v[68:71], v3, s[40:43], s44 offen nt
  s_add_u32 s45, s45, 1024
  s_and_b32 s45, s45, 0x7fff
  s_memrealtime s[14:15]
  s_waitcnt vmcnt(7)
  s_waitcnt lgkmcnt(0)
  s_sub_u32 s14, s14, s94
  s_cmp_ge_u32 s14, 950
  s_cbranch_scc1 L_fast14
  s_add_u32 s44, s12, s45
  buffer_load_dwordx4 v[72:75], v3, s[40:43], s44 offen nt
  s_add_u32 s45, s45, 1024
  s_and_b32 s45, s45, 0x7fff
  s_waitcnt vmcnt(7)
  s_add_u32 s44, s12, s45
  buffer_load_dwordx4 v[76:79], v3, s[40:43], s44 offen nt
  s_add_u32 s45, s45, 1024
  s_and_b32 s45, s45, 0x7fff
  s_branch L_wsk15
L_w15:
  s_branch L_w16
L_wsk15:
  s_memrealtime s[14:15]
  s_waitcnt vmcnt(7)
  s_waitcnt lgkmcnt(0)
  s_sub_u32 s14, s14, s94
  s_cmp_ge_u32 s14, 950
  s_cbranch_scc1 L_fast16
  s_add_u32 s44, s12, s45
  buffer_load_dwordx4 v[80:83], v3, s[40:43], s44 offen nt
  s_add_u32 s45, s45, 1024
  s_and_b32 s45, s45, 0x7fff
  s_waitcnt vmcnt(7)
  s_add_u32 s44, s12, s45
  buffer_load_dwordx4 v[84:87], v3, s[40:43], s44 offen nt
  s_add_u32 s45, s45, 1024
  s_and_b32 s45, s45, 0x7fff
  s_memrealtime s[14:15]
  s_waitcnt vmcnt(7)
  s_waitcnt lgkmcnt(0)
  s_sub_u32 s14, s14, s94
  s_cmp_ge_u32 s14, 950
  s_cbranch_scc1 L_fast18
  s_add_u32 s44, s12, s45
  buffer_load_dwordx4 v[88:91], v3, s[40:43], s44 offen nt
  s_add_u32 s45, s45, 1024
  s_and_b32 s45, s45, 0x7fff
  s_waitcnt vmcnt(7)
  s_add_u32 s44, s12, s45
  buffer_load_dwordx4 v[92:95], v3, s[40:43], s44 offen nt
  s_add_u32 s45, s45, 1024
  s_and_b32 s45, s45, 0x7fff
  s_memrealtime s[14:15]
  s_waitcnt vmcnt(7)
  s_waitcnt lgkmcnt(0)
  s_sub_u32 s14, s14, s94
  s_cmp_ge_u32 s14, 950
  s_cbranch_scc1 L_fast20
  s_add_u32 s44, s12, s45
  buffer_load_dwordx4 v[96:99], v3, s[40:43], s44 offen nt
  s_add_u32 s45, s45, 1024
  s_and_b32 s45, s45, 0x7fff
  s_waitcnt vmcnt(7)
  s_add_u32 s44, s12, s45
  buffer_load_dwordx4 v[100:103], v3, s[40:43], s44 offen nt
  s_add_u32 s45, s45, 1024
  s_and_b32 s45, s45, 0x7fff
  s_memrealtime s[14:15]
  s_waitcnt vmcnt(7)
  s_waitcnt lgkmcnt(0)
  s_sub_u32 s14, s14, s94
  s_cmp_ge_u32 s14, 950
  s_cbranch_scc1 L_fast22
  s_add_u32 s44, s12, s45
  buffer_load_dwordx4 v[104:107], v3, s[40:43], s44 offen nt
  s_add_u32 s45, s45, 1024
  s_and_b32 s45, s45, 0x7fff
  s_waitcnt vmcnt(7)
  s_add_u32 s44, s12, s45
  buffer_load_dwordx4 v[108:111], v3, s[40:43], s44 offen nt
  s_add_u32 s45, s45, 1024
  s_and_b32 s45, s45, 0x7fff
  s_memrealtime s[14:15]
  s_waitcnt vmcnt(7)
  s_waitcnt lgkmcnt(0)
  s_sub_u32 s14, s14, s94
  s_cmp_ge_u32 s14, 950
  s_cbranch_scc1 L_fast24
  s_add_u32 s44, s12, s45
  buffer_load_dwordx4 v[112:115], v3, s[40:43], s44 offen nt
  s_add_u32 s45, s45, 1024
  s_and_b32 s45, s45, 0x7fff
  s_waitcnt vmcnt(7)
  s_add_u32 s44, s12, s45
  buffer_load_dwordx4 v[116:119], v3, s[40:43], s44 offen nt
  s_add_u32 s45, s45, 1024
  s_and_b32 s45, s45, 0x7fff
  s_memrealtime s[14:15]
  s_waitcnt vmcnt(7)
  s_waitcnt lgkmcnt(0)
  s_sub_u32 s14, s14, s94
  s_cmp_ge_u32 s14, 950
  s_cbranch_scc1 L_fast26
  s_add_u32 s44, s12, s45
  buffer_load_dwordx4 v[120:123], v3, s[40:43], s44 offen nt
  s_add_u32 s45, s45, 1024
  s_and_b32 s45, s45, 0x7fff
  s_waitcnt vmcnt(7)
  s_add_u32 s44, s12, s45
  buffer_load_dwordx4 v[124:127], v3, s[40:43], s44 offen nt
  s_add_u32 s45, s45, 1024
  s_and_b32 s45, s45, 0x7fff
  s_memrealtime s[14:15]
  s_waitcnt vmcnt(7)
  s_waitcnt lgkmcnt(0)
  s_sub_u32 s14, s14, s94
  s_cmp_ge_u32 s14, 950
  s_cbranch_scc1 L_fast28
  s_add_u32 s44, s12, s45
  buffer_load_dwordx4 v[128:131], v3, s[40:43], s44 offen nt
  s_add_u32 s45, s45, 1024
  s_and_b32 s45, s45, 0x7fff
  s_waitcnt vmcnt(7)
  s_add_u32 s44, s12, s45
  buffer_load_dwordx4 v[132:135], v3, s[40:43], s44 offen nt
  s_add_u32 s45, s45, 1024
  s_and_b32 s45, s45, 0x7fff
  s_memrealtime s[14:15]
  s_waitcnt vmcnt(7)
  s_waitcnt lgkmcnt(0)
  s_sub_u32 s14, s14, s94
  s_cmp_ge_u32 s14, 950
  s_cbranch_scc1 L_fast30
  s_add_u32 s44, s12, s45
  buffer_load_dwordx4 v[136:139], v3, s[40:43], s44 offen nt
  s_add_u32 s45, s45, 1024
  s_and_b32 s45, s45, 0x7fff
  s_waitcnt vmcnt(7)
  s_add_u32 s44, s12, s45
  buffer_load_dwordx4 v[140:143], v3, s[40:43], s44 offen nt
  s_add_u32 s45, s45, 1024
  s_and_b32 s45, s45, 0x7fff
  s_branch L_issued
L_fast8:
  s_add_u32 s44, s12, s45
  buffer_load_dwordx4 v[48:51], v3, s[40:43], s44 offen nt
  s_add_u32 s45, s45, 1024
  s_and_b32 s45, s45, 0x7fff
  s_add_u32 s44, s12, s45
  buffer_load_dwordx4 v[52:55], v3, s[40:43], s44 offen nt
  s_add_u32 s45, s45, 1024
  s_and_b32 s45, s45, 0x7fff
L_fast10:
  s_add_u32 s44, s12, s45
  buffer_load_dwordx4 v[56:59], v3, s[40:43], s44 offen nt
  s_add_u32 s45, s45, 1024
  s_and_b32 s45, s45, 0x7fff
  s_add_u32 s44, s12, s45
  buffer_load_dwordx4 v[60:63], v3, s[40:43], s44 offen nt
  s_add_u32 s45, s45, 1024
  s_and_b32 s45, s45, 0x7fff
L_fast12:
  s_add_u32 s44, s12, s45
  buffer_load_dwordx4 v[64:67], v3, s[40:43], s44 offen nt
  s_add_u32 s45, s45, 1024
  s_and_b32 s45, s45, 0x7fff
  s_add_u32 s44, s12, s45
  buffer_load_dwordx4 v[68:71], v3, s[40:43], s44 offen nt
  s_add_u32 s45, s45, 1024
  s_and_b32 s45, s45, 0x7fff
L_fast14:
  s_add_u32 s44, s12, s45
  buffer_load_dwordx4 v[72:75], v3, s[40:43], s44 offen nt
  s_add_u32 s45, s45, 1024
  s_and_b32 s45, s45, 0x7fff
  s_add_u32 s44, s12, s45
  buffer_load_dwordx4 v[76:79], v3, s[40:43], s44 offen nt
  s_add_u32 s45, s45, 1024
  s_and_b32 s45, s45, 0x7fff
L_fast16:
  s_add_u32 s44, s12, s45
  buffer_load_dwordx4 v[80:83], v3, s[40:43], s44 offen nt
  s_add_u32 s45, s45, 1024
  s_and_b32 s45, s45, 0x7fff
  s_add_u32 s44, s12, s45
  buffer_load_dwordx4 v[84:87], v3, s[40:43], s44 offen nt
  s_add_u32 s45, s45, 1024
  s_and_b32 s45, s45, 0x7fff
L_fast18:
  s_add_u32 s44, s12, s45
  buffer_load_dwordx4 v[88:91], v3, s[40:43], s44 offen nt
  s_add_u32 s45, s45, 1024
  s_and_b32 s45, s45, 0x7fff
  s_add_u32 s44, s12, s45
  buffer_load_dwordx4 v[92:95], v3, s[40:43], s44 offen nt
  s_add_u32 s45, s45, 1024
  s_and_b32 s45, s45, 0x7fff
L_fast20:
  s_add_u32 s44, s12, s45
  buffer_load_dwordx4 v[96:99], v3, s[40:43], s44 offen nt
  s_add_u32 s45, s45, 1024
  s_and_b32 s45, s45, 0x7fff
  s_add_u32 s44, s12, s45
  buffer_load_dwordx4 v[100:103], v3, s[40:43], s44 offen nt
  s_add_u32 s45, s45, 1024
  s_and_b32 s45, s45, 0x7fff
L_fast22:
  s_add_u32 s44, s12, s45
  buffer_load_dwordx4 v[104:107], v3, s[40:43], s44 offen nt
  s_add_u32 s45, s45, 1024
  s_and_b32 s45, s45, 0x7fff
  s_add_u32 s44, s12, s45
  buffer_load_dwordx4 v[108:111], v3, s[40:43], s44 offen nt
  s_add_u32 s45, s45, 1024
  s_and_b32 s45, s45, 0x7fff
L_fast24:
  s_add_u32 s44, s12, s45
  buffer_load_dwordx4 v[112:115], v3, s[40:43], s44 offen nt
  s_add_u32 s45, s45, 1024
  s_and_b32 s45, s45, 0x7fff
  s_add_u32 s44, s12, s45
  buffer_load_dwordx4 v[116:119], v3, s[40:43], s44 offen nt
  s_add_u32 s45, s45, 1024
  s_and_b32 s45, s45, 0x7fff
L_fast26:
  s_add_u32 s44, s12, s45
  buffer_load_dwordx4 v[120:123], v3, s[40:43], s44 offen nt
  s_add_u32 s45, s45, 1024
  s_and_b32 s45, s45, 0x7fff
  s_add_u32 s44, s12, s45
  buffer_load_dwordx4 v[124:127], v3, s[40:43], s44 offen nt
  s_add_u32 s45, s45, 1024
  s_and_b32 s45, s45, 0x7fff
L_fast28:
  s_add_u32 s44, s12, s45
  buffer_load_dwordx4 v[128:131], v3, s[40:43], s44 offen nt
  s_add_u32 s45, s45, 1024
  s_and_b32 s45, s45, 0x7fff
  s_add_u32 s44, s12, s45
  buffer_load_dwordx4 v[132:135], v3, s[40:43], s44 offen nt
  s_add_u32 s45, s45, 1024
  s_and_b32 s45, s45, 0x7fff
L_fast30:
  s_add_u32 s44, s12, s45
  buffer_load_dwordx4 v[136:139], v3, s[40:43], s44 offen nt
  s_add_u32 s45, s45, 1024
  s_and_b32 s45, s45, 0x7fff
  s_add_u32 s44, s12, s45
  buffer_load_dwordx4 v[140:143], v3, s[40:43], s44 offen nt
  s_add_u32 s45, s45, 1024
  s_and_b32 s45, s45, 0x7fff
L_issued:
  ds_write_b32 v5, v2
  s_branch L_wsk16
L_w16:
  s_branch L_w17
L_wsk16:
L_vwave:
  v_and_b32 v6, 1, v0
  v_lshlrev_b32 v6, 4, v6
  v_mov_b32 v7, 0xffff
  v_lshlrev_b32 v6, v6, v7
  v_bfe_u32 v7, v0, 1, 2
  v_cmp_eq_u32 vcc, 0, v7
  s_nop 1
  v_cndmask_b32 v160, 0, v6, vcc
  v_cmp_eq_u32 vcc, 1, v7
  s_nop 1
  v_cndmask_b32 v161, 0, v6, vcc
  v_cmp_eq_u32 vcc, 2, v7
  s_nop 1
  v_cndmask_b32 v162, 0, v6, vcc
  v_cmp_eq_u32 vcc, 3, v7
  s_nop 1
  v_cndmask_b32 v163, 0, v6, vcc
  v_lshrrev_b32 v6, 4, v0
  v_lshlrev_b32 v6, 7, v6
  s_lshl_b32 s12, s10, 9
  v_add_u32 v6, s12, v6
  v_and_b32 v7, 15, v0
  v_lshlrev_b32 v7, 5, v7
  v_bfe_u32 v8, v0, 4, 1
  v_lshl_add_u32 v7, v8, 4, v7
  v_add_u32 v7, s12, v7
  s_lshl_b32 s12, s11, 9
  s_add_u32 s12, s12, 409600
  v_lshl_add_u32 v9, v0, 4, s12
  v_lshlrev_b32 v10, 4, v0
  v_mov_b32 v11, 0xff
  s_mov_b32 s9, 0
L_wl_62:
  ds_read_b32 v8, v1 offset:4
  s_waitcnt lgkmcnt(0)
  v_readfirstlane_b32 s8, v8
  s_cmp_lg_u32 s8, 0
  s_cbranch_scc1 L_wld_63
  s_sleep 1
  s_add_u32 s9, s9, 1
  s_cmp_lt_u32 s9, 2097152
  s_cbranch_scc1 L_wl_62
L_wld_63:
  s_mov_b32 s88, s8
  s_bfe_u32 s80, s8, 524288
  s_sub_u32 s84, 0x80, s80
  s_bfe_u32 s81, s8, 524296
  s_sub_u32 s85, 0x80, s81
  s_bfe_u32 s82, s8, 524304
  s_sub_u32 s86, 0x80, s82
  s_bfe_u32 s83, s8, 524312
  s_sub_u32 s87, 0x80, s83
  s_mov_b32 s89, 0x0c0c0400
  s_mov_b32 s90, 0x04000c0c
  s_mov_b32 s9, 0
L_wl_64:
  ds_read_b32 v8, v4 offset:32
  s_waitcnt lgkmcnt(0)
  v_readfirstlane_b32 s8, v8
  s_cmp_lg_u32 s8, 0
  s_cbranch_scc1 L_wld_65
  s_sleep 1
  s_add_u32 s9, s9, 1
  s_cmp_lt_u32 s9, 2097152
  s_cbranch_scc1 L_wl_64
L_wld_65:
  ds_read_b128 v[144:147], v6 offset:2560
  ds_read_b128 v[148:151], v6 offset:2576
  s_waitcnt lgkmcnt(1)
  v_and_b32 v152, v144, v160
  v_and_b32 v153, v144, v161
  v_and_b32 v154, v144, v162
  v_and_b32 v155, v144, v163
  s_waitcnt vmcnt(31)
  s_nop 0
  v_mfma_f32_16x16x32_bf16 v[164:167], v[152:155], v[16:19], 0
  v_and_b32 v156, v145, v160
  v_and_b32 v157, v145, v161
  v_and_b32 v158, v145, v162
  v_and_b32 v159, v145, v163
  s_waitcnt vmcnt(30)
  s_nop 0
  v_mfma_f32_16x16x32_bf16 v[164:167], v[156:159], v[20:23], v[164:167]
  v_and_b32 v152, v146, v160
  v_and_b32 v153, v146, v161
  v_and_b32 v154, v146, v162
  v_and_b32 v155, v146, v163
  s_waitcnt vmcnt(29)
  s_nop 0
  v_mfma_f32_16x16x32_bf16 v[164:167], v[152:155], v[24:27], v[164:167]
  v_and_b32 v156, v147, v160
  v_and_b32 v157, v147, v161
  v_and_b32 v158, v147, v162
  v_and_b32 v159, v147, v163
  s_waitcnt vmcnt(28)
  s_nop 0
  v_mfma_f32_16x16x32_bf16 v[164:167], v[156:159], v[28:31], v[164:167]
  ds_read_b128 v[144:147], v6 offset:2592
  s_waitcnt lgkmcnt(1)
  v_and_b32 v152, v148, v160
  v_and_b32 v153, v148, v161
  v_and_b32 v154, v148, v162
  v_and_b32 v155, v148, v163
  s_waitcnt vmcnt(27)
  s_nop 0
  v_mfma_f32_16x16x32_bf16 v[164:167], v[152:155], v[32:35], v[164:167]
  v_and_b32 v156, v149, v160
  v_and_b32 v157, v149, v161
  v_and_b32 v158, v149, v162
  v_and_b32 v159, v149, v163
  s_waitcnt vmcnt(26)
  s_nop 0
  v_mfma_f32_16x16x32_bf16 v[164:167], v[156:159], v[36:39], v[164:167]
  v_and_b32 v152, v150, v160
  v_and_b32 v153, v150, v161
  v_and_b32 v154, v150, v162
  v_and_b32 v155, v150, v163
  s_waitcnt vmcnt(25)
  s_nop 0
  v_mfma_f32_16x16x32_bf16 v[164:167], v[152:155], v[40:43], v[164:167]
  v_and_b32 v156, v151, v160
  v_and_b32 v157, v151, v161
  v_and_b32 v158, v151, v162
  v_and_b32 v159, v151, v163
  s_waitcnt vmcnt(24)
  s_nop 0
  v_mfma_f32_16x16x32_bf16 v[164:167], v[156:159], v[44:47], v[164:167]
  ds_read_b128 v[148:151], v6 offset:2608
  s_waitcnt lgkmcnt(1)
  v_and_b32 v152, v144, v160
  v_and_b32 v153, v144, v161
  v_and_b32 v154, v144, v162
  v_and_b32 v155, v144, v163
  s_waitcnt vmcnt(23)
  s_nop 0
  v_mfma_f32_16x16x32_bf16 v[164:167], v[152:155], v[48:51], v[164:167]
  v_and_b32 v156, v145, v160
  v_and_b32 v157, v145, v161
  v_and_b32 v158, v145, v162
  v_and_b32 v159, v145, v163
  s_waitcnt vmcnt(22)
  s_nop 0
  v_mfma_f32_16x16x32_bf16 v[164:167], v[156:159], v[52:55], v[164:167]
  v_and_b32 v152, v146, v160
  v_and_b32 v153, v146, v161
  v_and_b32 v154, v146, v162
  v_and_b32 v155, v146, v163
  s_waitcnt vmcnt(21)
  s_nop 0
  v_mfma_f32_16x16x32_bf16 v[164:167], v[152:155], v[56:59], v[164:167]
  v_and_b32 v156, v147, v160
  v_and_b32 v157, v147, v161
  v_and_b32 v158, v147, v162
  v_and_b32 v159, v147, v163
  s_waitcnt vmcnt(20)
  s_nop 0
  v_mfma_f32_16x16x32_bf16 v[164:167], v[156:159], v[60:63], v[164:167]
  ds_read_b128 v[144:147], v6 offset:2624
  s_waitcnt lgkmcnt(1)
  v_and_b32 v152, v148, v160
  v_and_b32 v153, v148, v161
  v_and_b32 v154, v148, v162
  v_and_b32 v155, v148, v163
  s_waitcnt vmcnt(19)
  s_nop 0
  v_mfma_f32_16x16x32_bf16 v[164:167], v[152:155], v[64:67], v[164:167]
  v_and_b32 v156, v149, v160
  v_and_b32 v157, v149, v161
  v_and_b32 v158, v149, v162
  v_and_b32 v159, v149, v163
  s_waitcnt vmcnt(18)
  s_nop 0
  v_mfma_f32_16x16x32_bf16 v[164:167], v[156:159], v[68:71], v[164:167]
  v_and_b32 v152, v150, v160
  v_and_b32 v153, v150, v161
  v_and_b32 v154, v150, v162
  v_and_b32 v155, v150, v163
  s_waitcnt vmcnt(17)
  s_nop 0
  v_mfma_f32_16x16x32_bf16 v[164:167], v[152:155], v[72:75], v[164:167]
  v_and_b32 v156, v151, v160
  v_and_b32 v157, v151, v161
  v_and_b32 v158, v151, v162
  v_and_b32 v159, v151, v163
  s_waitcnt vmcnt(16)
  s_nop 0
  v_mfma_f32_16x16x32_bf16 v[164:167], v[156:159], v[76:79], v[164:167]
  s_branch L_wsk17
L_w17:
  s_branch L_w18
L_wsk17:
  ds_read_b128 v[148:151], v6 offset:2640
  s_waitcnt lgkmcnt(1)
  v_and_b32 v152, v144, v160
  v_and_b32 v153, v144, v161
  v_and_b32 v154, v144, v162
  v_and_b32 v155, v144, v163
  s_waitcnt vmcnt(15)
  s_nop 0
  v_mfma_f32_16x16x32_bf16 v[164:167], v[152:155], v[80:83], v[164:167]
  v_and_b32 v156, v145, v160
  v_and_b32 v157, v145, v161
  v_and_b32 v158, v145, v162
  v_and_b32 v159, v145, v163
  s_waitcnt vmcnt(14)
  s_nop 0
  v_mfma_f32_16x16x32_bf16 v[164:167], v[156:159], v[84:87], v[164:167]
  v_and_b32 v152, v146, v160
  v_and_b32 v153, v146, v161
  v_and_b32 v154, v146, v162
  v_and_b32 v155, v146, v163
  s_waitcnt vmcnt(13)
  s_nop 0
  v_mfma_f32_16x16x32_bf16 v[164:167], v[152:155], v[88:91], v[164:167]
  v_and_b32 v156, v147, v160
  v_and_b32 v157, v147, v161
  v_and_b32 v158, v147, v162
  v_and_b32 v159, v147, v163
  s_waitcnt vmcnt(12)
  s_nop 0
  v_mfma_f32_16x16x32_bf16 v[164:167], v[156:159], v[92:95], v[164:167]
  ds_read_b128 v[144:147], v6 offset:2656
  s_waitcnt lgkmcnt(1)
  v_and_b32 v152, v148, v160
  v_and_b32 v153, v148, v161
  v_and_b32 v154, v148, v162
  v_and_b32 v155, v148, v163
  s_waitcnt vmcnt(11)
  s_nop 0
  v_mfma_f32_16x16x32_bf16 v[164:167], v[152:155], v[96:99], v[164:167]
  v_and_b32 v156, v149, v160
  v_and_b32 v157, v149, v161
  v_and_b32 v158, v149, v162
  v_and_b32 v159, v149, v163
  s_waitcnt vmcnt(10)
  s_nop 0
  v_mfma_f32_16x16x32_bf16 v[164:167], v[156:159], v[100:103], v[164:167]
  v_and_b32 v152, v150, v160
  v_and_b32 v153, v150, v161
  v_and_b32 v154, v150, v162
  v_and_b32 v155, v150, v163
  s_waitcnt vmcnt(9)
  s_nop 0
  v_mfma_f32_16x16x32_bf16 v[164:167], v[152:155], v[104:107], v[164:167]
  v_and_b32 v156, v151, v160
  v_and_b32 v157, v151, v161
  v_and_b32 v158, v151, v162
  v_and_b32 v159, v151, v163
  s_waitcnt vmcnt(8)
  s_nop 0
  v_mfma_f32_16x16x32_bf16 v[164:167], v[156:159], v[108:111], v[164:167]
  s_mov_b32 s9, 0
L_wl_66:
  ds_read_b128 v[16:19], v1 offset:32
  s_waitcnt lgkmcnt(0)
  v_and_b32 v16, v16, v17
  v_and_b32 v18, v18, v19
  v_and_b32 v16, v16, v18
  s_nop 0
  v_readfirstlane_b32 s8, v16
  s_cmp_lg_u32 s8, 0
  s_cbranch_scc1 L_wld_67
  s_sleep 1
  s_add_u32 s9, s9, 1
  s_cmp_lt_u32 s9, 2097152
  s_cbranch_scc1 L_wl_66
L_wld_67:
  s_lshl_b32 s12, s10, 2
  v_mov_b32 v12, s12
  ds_read_b128 v[16:19], v1 offset:112
  ds_read_b32 v13, v12 offset:112
  s_waitcnt lgkmcnt(0)
  v_max3_f32 v16, v16, v17, v18
  v_max_f32 v16, v16, v19
  v_sub_f32 v13, v13, v16
  v_mul_f32 v13, 0x3fb8aa3b, v13
  v_exp_f32 v13, v13
  ds_read_b128 v[148:151], v6 offset:2672
  s_waitcnt lgkmcnt(1)
  v_and_b32 v152, v144, v160
  v_and_b32 v153, v144, v161
  v_and_b32 v154, v144, v162
  v_and_b32 v155, v144, v163
  s_waitcnt vmcnt(7)
  s_nop 0
  v_mfma_f32_16x16x32_bf16 v[164:167], v[152:155], v[112:115], v[164:167]
  v_and_b32 v156, v145, v160
  v_and_b32 v157, v145, v161
  v_and_b32 v158, v145, v162
  v_and_b32 v159, v145, v163
  s_waitcnt vmcnt(6)
  s_nop 0
  v_mfma_f32_16x16x32_bf16 v[164:167], v[156:159], v[116:119], v[164:167]
  v_and_b32 v152, v146, v160
  v_and_b32 v153, v146, v161
  v_and_b32 v154, v146, v162
  v_and_b32 v155, v146, v163
  s_waitcnt vmcnt(5)
  s_nop 0
  v_mfma_f32_16x16x32_bf16 v[164:167], v[152:155], v[120:123], v[164:167]
  v_and_b32 v156, v147, v160
  v_and_b32 v157, v147, v161
  v_and_b32 v158, v147, v162
  v_and_b32 v159, v147, v163
  s_waitcnt vmcnt(4)
  s_nop 0
  v_mfma_f32_16x16x32_bf16 v[164:167], v[156:159], v[124:127], v[164:167]
  s_waitcnt lgkmcnt(0)
  v_and_b32 v152, v148, v160
  v_and_b32 v153, v148, v161
  v_and_b32 v154, v148, v162
  v_and_b32 v155, v148, v163
  s_waitcnt vmcnt(3)
  s_nop 0
  v_mfma_f32_16x16x32_bf16 v[164:167], v[152:155], v[128:131], v[164:167]
  v_and_b32 v156, v149, v160
  v_and_b32 v157, v149, v161
  v_and_b32 v158, v149, v162
  v_and_b32 v159, v149, v163
  s_waitcnt vmcnt(2)
  s_nop 0
  v_mfma_f32_16x16x32_bf16 v[164:167], v[156:159], v[132:135], v[164:167]
  v_and_b32 v152, v150, v160
  v_and_b32 v153, v150, v161
  v_and_b32 v154, v150, v162
  v_and_b32 v155, v150, v163
  s_waitcnt vmcnt(1)
  s_nop 0
  v_mfma_f32_16x16x32_bf16 v[164:167], v[152:155], v[136:139], v[164:167]
  v_and_b32 v156, v151, v160
  v_and_b32 v157, v151, v161
  v_and_b32 v158, v151, v162
  v_and_b32 v159, v151, v163
  s_waitcnt vmcnt(0)
  s_nop 0
  v_mfma_f32_16x16x32_bf16 v[164:167], v[156:159], v[140:143], v[164:167]
  s_nop 7
  v_mul_f32 v164, v164, v13
  v_mul_f32 v165, v165, v13
  v_mul_f32 v166, v166, v13
  v_mul_f32 v167, v167, v13
  s_mov_b64 exec, 0xffffffff
  ds_write_b128 v7, v[164:167] offset:4608
  s_mov_b64 exec, 1
  ds_add_rtn_u32 v8, v1, v2 offset:16
  s_mov_b64 exec, -1
  s_waitcnt lgkmcnt(0)
  v_readfirstlane_b32 s8, v8
  s_cmp_eq_u32 s8, 3
  s_cbranch_scc0 L_v_done
  s_mov_b64 exec, 0xffffffff
  ds_read_b128 v[16:19], v10 offset:4608
  ds_read_b128 v[20:23], v10 offset:5120
  ds_read_b128 v[24:27], v10 offset:5632
  ds_read_b128 v[28:31], v10 offset:6144
  s_waitcnt lgkmcnt(0)
  v_add_f32 v16, v16, v20
  v_add_f32 v24, v24, v28
  v_add_f32 v17, v17, v21
  v_add_f32 v25, v25, v29
  v_add_f32 v18, v18, v22
  v_add_f32 v26, v26, v30
  v_add_f32 v19, v19, v23
  v_add_f32 v27, v27, v31
  v_add_f32 v16, v16, v24
  v_add_f32 v17, v17, v25
  v_add_f32 v18, v18, v26
  v_add_f32 v19, v19, v27
  v_add_u32 v16, s84, v16
  v_add_u32 v17, s85, v17
  v_add_u32 v18, s86, v18
  v_add_u32 v19, s87, v19
  v_bfi_b32 v16, v11, s80, v16
  v_bfi_b32 v17, v11, s81, v17
  v_bfi_b32 v18, v11, s82, v18
  v_bfi_b32 v19, v11, s83, v19
  global_store_dwordx4 v9, v[16:19], s[36:37] sc1
  s_mov_b64 exec, -1
L_v_done:
  s_endpgm
L_w18:
  s_branch L_wdone
L_end:
  s_endpgm
.section .rodata,"a"
.p2align 6
.amdhsa_kernel recurrent_scan__sliding_block_cached__dense_activation_relu__decode_kernel
  .amdhsa_next_free_vgpr 168
  .amdhsa_next_free_sgpr 102
  .amdhsa_accum_offset 168
  .amdhsa_group_segment_fixed_size 0
  .amdhsa_kernarg_size 88
  .amdhsa_user_sgpr_count 2
  .amdhsa_user_sgpr_kernarg_segment_ptr 1
  .amdhsa_system_sgpr_workgroup_id_x 1
.end_amdhsa_kernel
```
